```python
import torch

def _softmax(x, axis=-1):
    return torch.softmax(x, dim=axis)
def _gelu(x):
    return torch.nn.functional.gelu(x, approximate="tanh")
def _silu(x):
    return torch.nn.functional.silu(x)
def _sigmoid(x):
    return torch.sigmoid(x)
def _layernorm(x, axis=-1, eps=1e-5):
    m = x.mean(dim=axis, keepdim=True)
    v = x.var(dim=axis, keepdim=True, unbiased=False)
    return (x - m) / torch.sqrt(v + eps)
def _scatter_add(tgt, idx, src, axis=0):
    return tgt.clone().index_add_(axis, idx, src)
def _segment_sum(src, seg, n):
    out = torch.zeros((n,) + src.shape[1:], dtype=src.dtype)
    return out.index_add_(0, seg, src)
def _pad(x, pw):
    flat = tuple(v for pair in reversed(pw) for v in pair)
    return torch.nn.functional.pad(x, flat)

kernel_name = 'recurrent_scan__gqa_block_cached__dense_activation_relu__decode'

def setup_inputs():

    _w = (lambda a: (lambda t: t.to(torch.bfloat16) if t.is_floating_point() else t)(torch.as_tensor(a)))
    def _A_setup():
        B, Sq, D = 8, 1, 448
        Hq, Hkv, Sk, Dh = 16, 8, 4096, 256
        assert Hq % Hkv == 0, (Hq, Hkv)
        return {
            "x": _w((lambda *s: torch.randn(*s, dtype=torch.bfloat16) * 0.05)(B, Sq, D)),
            "k_cache": _w((lambda *s: torch.randn(*s, dtype=torch.bfloat16) * 0.8)(B, Hkv, Sk, Dh)),
            "v_cache": _w((lambda *s: torch.randn(*s, dtype=torch.bfloat16) * 0.8)(B, Hkv, Sk, Dh)),
            "wq": _w((lambda *s: torch.randn(*s, dtype=torch.bfloat16) * 0.8)(D, Hq * Dh) * (D ** -0.5)),
            "wo": _w((lambda *s: torch.randn(*s, dtype=torch.bfloat16) * 0.8)(Hq * Dh, D) * ((Hq * Dh) ** -0.5)),
        }
    _A_in = _A_setup()

    def _B_setup():
        B, S, D, Dff = 8, 1, 448, 1792
        return {
            "x": _w((lambda *s: torch.randn(*s, dtype=torch.bfloat16) * 0.05)(B, S, D)),
            "w1": _w((lambda *s: torch.randn(*s, dtype=torch.bfloat16) * 0.2)(D, Dff)),
            "w2": _w((lambda *s: torch.randn(*s, dtype=torch.bfloat16) * 0.2)(Dff, D)),
        }
    _B_in = _B_setup()

    return {
        "A_x": _A_in["x"],
        "A_k_cache": _A_in["k_cache"],
        "A_v_cache": _A_in["v_cache"],
        "A_wq": _A_in["wq"],
        "A_wo": _A_in["wo"],
        "B_x": _B_in["x"],
        "B_w1": _B_in["w1"],
        "B_w2": _B_in["w2"],
    }

def reference(A_x, A_k_cache, A_v_cache, A_wq, A_wo, B_x, B_w1, B_w2):
    def _A_ref(x, k_cache, v_cache, wq, wo):
        B, Sq, D = x.shape
        Hq, Dh = 16, 256
        Hkv = k_cache.shape[1]
        rep = Hq // Hkv
        q = (lambda x, *d: x.permute(*d))((x @ wq).reshape(B, Sq, Hq, Dh), 0, 2, 1, 3)
        k = (lambda x, n, axis: torch.repeat_interleave(x, n, dim=axis))(k_cache, rep, axis=1)
        v = (lambda x, n, axis: torch.repeat_interleave(x, n, dim=axis))(v_cache, rep, axis=1)
        scores = torch.einsum("bhqd,bhkd->bhqk", q, k) * (Dh ** -0.5)
        p = _softmax(scores, axis=-1)
        o = torch.einsum("bhqk,bhkd->bhqd", p, v)
        return (lambda x, *d: x.permute(*d))(o, 0, 2, 1, 3).reshape(B, Sq, Hq * Dh) @ wo

    def _B_ref(x, w1, w2):
        h = torch.einsum("bsd,df->bsf", x, w1)
        zero = torch.zeros_like(h)
        h = torch.maximum(h, zero)
        return torch.einsum("bsf,fd->bsd", h, w2)

    x = A_x
    xn = _layernorm(x, axis=-1)
    s = _A_ref(xn, A_k_cache, A_v_cache, A_wq, A_wo)
    g = _silu(_B_ref(xn, B_w1, B_w2))
    return x + s * g
```

```asm
; @launch grid=(256,1,1) block=(512,1,1) lds=149504
.amdgcn_target "amdgcn-amd-amdhsa--gfx950"
.text
.globl recurrent_scan__gqa_block_cached__dense_activation_relu__decode_kernel
.p2align 8
.type recurrent_scan__gqa_block_cached__dense_activation_relu__decode_kernel,@function
recurrent_scan__gqa_block_cached__dense_activation_relu__decode_kernel:
  s_cmp_ge_u32 s2, 256
  s_cbranch_scc1 L_end
  s_setprio 3
  s_load_dwordx16 s[64:79], s[0:1], 0
  s_load_dwordx4 s[80:83], s[0:1], 64
  s_load_dwordx2 s[84:85], s[0:1], 80
  v_lshrrev_b32 v1, 6, v0
  v_and_b32 v0, 63, v0
  s_and_b32 s4, s2, 7
  v_readfirstlane_b32 s3, v1
  s_lshr_b32 s5, s2, 3
  s_and_b32 s6, s5, 7
  s_lshr_b32 s7, s5, 3
  s_lshl_b32 s86, s4, 5
  s_add_u32 s86, s86, s5
  s_lshl_b32 s48, s7, 1
  s_sub_u32 s4, s4, s48
  s_and_b32 s4, s4, 7
  s_lshl_b32 s91, s6, 3
  s_add_u32 s91, s91, s4
  s_lshl_b32 s91, s91, 2
  s_add_u32 s91, s91, s7
  s_lshr_b32 s50, s91, 2
  s_lshl_b32 s50, s50, 21
  s_lshl_b32 s40, s7, 6
  v_and_b32 v7, 15, v0
  v_lshrrev_b32 v8, 4, v0
  s_cmp_lt_u32 s3, 4
  s_cbranch_scc0 L_front_s
  s_mul_i32 s51, s3, 1792
  v_lshrrev_b32 v9, 5, v0
  v_mul_u32_u24 v9, 896, v9
  v_and_b32 v10, 31, v0
  v_lshl_add_u32 v9, v10, 5, v9
  v_add_u32 v9, s51, v9
  v_cmp_gt_u32 vcc, 28, v10
  v_mov_b32 v10, 0x7fffff00
  v_lshrrev_b32 v11, 1, v0
  v_lshlrev_b32 v11, 13, v11
  v_cndmask_b32 v9, v10, v9, vcc
  v_and_b32 v12, 1, v0
  v_lshl_add_u32 v11, v12, 4, v11
  s_lshl_b32 s48, s86, 5
  s_lshl_b32 s56, s3, 20
  s_add_u32 s57, s56, 262144
  s_add_u32 s58, s56, 524288
  s_add_u32 s59, s56, 786432
  s_mov_b32 s18, 7168
  s_mov_b32 s19, 0x20000
  s_sub_u32 s22, 3670016, s48
  s_mov_b32 s23, 0x20000
  v_mov_b32 v20, 125696
  v_mov_b32 v24, 0
  v_mov_b32 v25, 0
  v_mov_b32 v26, 0
  v_mov_b32 v27, 0
  v_mov_b32 v28, 8
  v_mov_b32 v29, 0
  v_mov_b32 v30, 0
  v_mov_b32 v31, 0
  ds_write_b128 v20, v[24:27]
  ds_write_b128 v20, v[28:31] offset:16
  ds_write_b128 v20, v[24:27] offset:32
  ds_write_b128 v20, v[24:27] offset:64
  ds_write_b128 v20, v[24:27] offset:80
  s_waitcnt lgkmcnt(0)
  s_mov_b32 s16, s64
  s_mov_b32 s17, s65
  s_add_u32 s20, s70, s48
  s_addc_u32 s21, s71, 0
  buffer_load_dwordx4 v[16:19], v9, s[16:19], 0 offen
  buffer_load_dwordx4 v[20:23], v9, s[16:19], 0 offen offset:16
  buffer_load_dwordx4 v[64:67], v11, s[20:23], s56 offen nt
  buffer_load_dwordx4 v[68:71], v11, s[20:23], s57 offen nt
  buffer_load_dwordx4 v[72:75], v11, s[20:23], s58 offen nt
  buffer_load_dwordx4 v[76:79], v11, s[20:23], s59 offen nt
  s_load_dwordx2 s[94:95], s[84:85], 0
  s_barrier
  s_branch L_front_h
L_front_s:
  v_lshlrev_b32 v1, 9, v7
  v_lshl_add_u32 v1, v8, 4, v1
  v_lshlrev_b32 v2, 11, v8
  v_lshl_add_u32 v2, v7, 4, v2
  s_mov_b32 s10, 0x200000
  s_mov_b32 s11, 0x20000
  s_mov_b32 s14, 0x200000
  s_mov_b32 s15, 0x20000
  s_and_b32 s51, s3, 3
  s_add_u32 s51, s51, s40
  s_lshl_b32 s51, s51, 13
  s_setprio 1
  s_waitcnt lgkmcnt(0)
  s_add_u32 s8, s66, s50
  s_addc_u32 s9, s67, 0
  s_add_u32 s12, s68, s50
  s_addc_u32 s13, s69, 0
  s_load_dwordx2 s[94:95], s[84:85], 0
  s_mov_b32 s36, s84
  s_mov_b32 s37, s85
  s_mov_b32 s38, 4194304
  s_mov_b32 s39, 0x20000
  s_barrier
  s_branch L_stream
L_front_h:
  s_lshr_b32 s87, s91, 2
  s_and_b32 s48, s87, 3
  s_cmp_eq_u32 s48, s7
  s_cselect_b32 s89, 1, 0
  s_cmp_lt_u32 s87, 56
  s_cselect_b32 s89, s89, 0
  s_cmp_ge_u32 s87, 28
  s_cselect_b32 s48, 1, 0
  s_lshl_b32 s89, s89, s48
  s_sub_u32 s49, s87, 28
  s_and_b32 s49, s49, 31
  s_mul_i32 s48, s49, 37
  s_lshr_b32 s98, s48, 8
  s_mul_i32 s48, s98, 7
  s_sub_u32 s88, s49, s48
  s_lshl_b32 s90, s4, 2
  s_add_u32 s90, s90, s7
  s_mov_b32 s93, 0x3db8aa3b
  s_lshl_b32 s48, s87, 7
  s_mul_i32 s49, s98, 401408
  s_lshl_b32 s28, s88, 7
  s_add_u32 s49, s49, s28
  s_cmp_eq_u32 s89, 2
  s_cselect_b32 s48, s49, s48
  s_cselect_b32 s28, s78, s76
  s_cselect_b32 s29, s79, s77
  s_movk_i32 s99, 3584
  s_cselect_b32 s99, 896, s99
  s_add_u32 s24, s28, s48
  s_addc_u32 s25, s29, 0
  s_sub_u32 s49, 1605632, s48
  s_cmp_eq_u32 s89, 0
  s_cselect_b32 s26, 0, s49
  s_mov_b32 s27, 0x20000
  s_mul_i32 s48, s4, 458752
  s_mul_i32 s49, s7, 57344
  s_add_u32 s48, s48, s49
  s_add_u32 s32, s72, s48
  s_addc_u32 s33, s73, 0
  s_sub_u32 s34, 3670016, s48
  s_mov_b32 s35, 0x20000
  s_mov_b32 s36, s84
  s_mov_b32 s37, s85
  s_mov_b32 s38, 4194304
  s_mov_b32 s39, 0x20000
  s_mov_b32 s44, s80
  s_mov_b32 s45, s81
  s_mov_b32 s46, 7168
  s_mov_b32 s47, 0x20000
  s_waitcnt vmcnt(4)
  v_lshlrev_b32 v24, 16, v16
  v_and_b32 v25, 0xffff0000, v16
  v_lshlrev_b32 v26, 16, v17
  v_and_b32 v27, 0xffff0000, v17
  v_lshlrev_b32 v28, 16, v18
  v_and_b32 v29, 0xffff0000, v18
  v_lshlrev_b32 v30, 16, v19
  v_and_b32 v31, 0xffff0000, v19
  v_lshlrev_b32 v32, 16, v20
  v_and_b32 v33, 0xffff0000, v20
  v_lshlrev_b32 v34, 16, v21
  v_and_b32 v35, 0xffff0000, v21
  v_lshlrev_b32 v36, 16, v22
  v_and_b32 v37, 0xffff0000, v22
  v_lshlrev_b32 v38, 16, v23
  v_and_b32 v39, 0xffff0000, v23
  v_add_f32 v40, v24, v25
  v_add_f32 v41, v26, v27
  v_add_f32 v42, v28, v29
  v_add_f32 v43, v30, v31
  v_add_f32 v44, v32, v33
  v_add_f32 v45, v34, v35
  v_add_f32 v46, v36, v37
  v_add_f32 v47, v38, v39
  v_add_f32 v40, v40, v44
  v_add_f32 v41, v41, v45
  v_add_f32 v42, v42, v46
  v_add_f32 v43, v43, v47
  v_add_f32 v40, v40, v42
  v_add_f32 v41, v41, v43
  v_add_f32 v40, v40, v41
  s_nop 1
  v_add_f32_dpp v40, v40, v40 quad_perm:[1,0,3,2] row_mask:0xf bank_mask:0xf
  s_nop 1
  v_add_f32_dpp v40, v40, v40 quad_perm:[2,3,0,1] row_mask:0xf bank_mask:0xf
  s_nop 1
  v_add_f32_dpp v40, v40, v40 row_half_mirror row_mask:0xf bank_mask:0xf
  s_nop 1
  v_add_f32_dpp v40, v40, v40 row_mirror row_mask:0xf bank_mask:0xf
  v_mov_b32 v41, v40
  s_nop 1
  v_permlane16_swap_b32 v40, v41
  s_nop 1
  v_add_f32 v40, v40, v41
  v_mul_f32 v40, 0x3b124925, v40
  v_sub_f32 v44, v24, v40
  v_sub_f32 v45, v25, v40
  v_sub_f32 v46, v26, v40
  v_sub_f32 v47, v27, v40
  v_sub_f32 v48, v28, v40
  v_sub_f32 v49, v29, v40
  v_sub_f32 v50, v30, v40
  v_sub_f32 v51, v31, v40
  v_sub_f32 v52, v32, v40
  v_sub_f32 v53, v33, v40
  v_sub_f32 v54, v34, v40
  v_sub_f32 v55, v35, v40
  v_sub_f32 v56, v36, v40
  v_sub_f32 v57, v37, v40
  v_sub_f32 v58, v38, v40
  v_sub_f32 v59, v39, v40
  v_mul_f32 v42, v44, v44
  v_mul_f32 v43, v45, v45
  v_fmac_f32 v42, v46, v46
  v_fmac_f32 v43, v47, v47
  v_fmac_f32 v42, v48, v48
  v_fmac_f32 v43, v49, v49
  v_fmac_f32 v42, v50, v50
  v_fmac_f32 v43, v51, v51
  v_fmac_f32 v42, v52, v52
  v_fmac_f32 v43, v53, v53
  v_fmac_f32 v42, v54, v54
  v_fmac_f32 v43, v55, v55
  v_fmac_f32 v42, v56, v56
  v_fmac_f32 v43, v57, v57
  v_fmac_f32 v42, v58, v58
  v_fmac_f32 v43, v59, v59
  s_mov_b32 s56, 0x0fffffff
  s_mov_b32 s57, 0x0fffffff
  v_add_f32 v42, v42, v43
  v_cndmask_b32 v42, 0, v42, s[56:57]
  s_nop 1
  v_add_f32_dpp v42, v42, v42 quad_perm:[1,0,3,2] row_mask:0xf bank_mask:0xf
  s_nop 1
  v_add_f32_dpp v42, v42, v42 quad_perm:[2,3,0,1] row_mask:0xf bank_mask:0xf
  s_nop 1
  v_add_f32_dpp v42, v42, v42 row_half_mirror row_mask:0xf bank_mask:0xf
  s_nop 1
  v_add_f32_dpp v42, v42, v42 row_mirror row_mask:0xf bank_mask:0xf
  v_mov_b32 v41, v42
  s_nop 1
  v_permlane16_swap_b32 v42, v41
  s_nop 1
  v_add_f32 v42, v42, v41
  v_mul_f32 v42, 0x3b124925, v42
  v_cvt_pk_bf16_f32 v41, v40, v42
  v_lshlrev_b32 v40, 16, v41
  v_and_b32 v42, 0xffff0000, v41
  v_add_f32 v42, 0x3727c5ac, v42
  v_cvt_pk_bf16_f32 v42, v42, v42
  v_lshlrev_b32 v42, 16, v42
  v_sqrt_f32 v42, v42
  s_nop 0
  v_cvt_pk_bf16_f32 v42, v42, v42
  v_lshlrev_b32 v42, 16, v42
  v_rcp_f32 v42, v42
  v_sub_f32 v44, v24, v40
  v_sub_f32 v45, v25, v40
  v_sub_f32 v46, v26, v40
  v_sub_f32 v47, v27, v40
  v_sub_f32 v48, v28, v40
  v_sub_f32 v49, v29, v40
  v_sub_f32 v50, v30, v40
  v_sub_f32 v51, v31, v40
  v_sub_f32 v52, v32, v40
  v_sub_f32 v53, v33, v40
  v_sub_f32 v54, v34, v40
  v_sub_f32 v55, v35, v40
  v_sub_f32 v56, v36, v40
  v_sub_f32 v57, v37, v40
  v_sub_f32 v58, v38, v40
  v_sub_f32 v59, v39, v40
  v_cvt_pk_bf16_f32 v16, v44, v45
  v_cvt_pk_bf16_f32 v17, v46, v47
  v_cvt_pk_bf16_f32 v18, v48, v49
  v_cvt_pk_bf16_f32 v19, v50, v51
  v_cvt_pk_bf16_f32 v20, v52, v53
  v_cvt_pk_bf16_f32 v21, v54, v55
  v_cvt_pk_bf16_f32 v22, v56, v57
  v_cvt_pk_bf16_f32 v23, v58, v59
  v_lshlrev_b32 v44, 16, v16
  v_and_b32 v45, 0xffff0000, v16
  v_lshlrev_b32 v46, 16, v17
  v_and_b32 v47, 0xffff0000, v17
  v_lshlrev_b32 v48, 16, v18
  v_and_b32 v49, 0xffff0000, v18
  v_lshlrev_b32 v50, 16, v19
  v_and_b32 v51, 0xffff0000, v19
  v_lshlrev_b32 v52, 16, v20
  v_and_b32 v53, 0xffff0000, v20
  v_lshlrev_b32 v54, 16, v21
  v_and_b32 v55, 0xffff0000, v21
  v_lshlrev_b32 v56, 16, v22
  v_and_b32 v57, 0xffff0000, v22
  v_lshlrev_b32 v58, 16, v23
  v_and_b32 v59, 0xffff0000, v23
  v_mul_f32 v44, v44, v42
  v_mul_f32 v45, v45, v42
  v_mul_f32 v46, v46, v42
  v_mul_f32 v47, v47, v42
  v_mul_f32 v48, v48, v42
  v_mul_f32 v49, v49, v42
  v_mul_f32 v50, v50, v42
  v_mul_f32 v51, v51, v42
  v_mul_f32 v52, v52, v42
  v_mul_f32 v53, v53, v42
  v_mul_f32 v54, v54, v42
  v_mul_f32 v55, v55, v42
  v_mul_f32 v56, v56, v42
  v_mul_f32 v57, v57, v42
  v_mul_f32 v58, v58, v42
  v_mul_f32 v59, v59, v42
  v_cvt_pk_bf16_f32 v16, v44, v45
  v_cvt_pk_bf16_f32 v17, v46, v47
  v_cvt_pk_bf16_f32 v18, v48, v49
  v_cvt_pk_bf16_f32 v19, v50, v51
  v_cvt_pk_bf16_f32 v20, v52, v53
  v_cvt_pk_bf16_f32 v21, v54, v55
  v_cvt_pk_bf16_f32 v22, v56, v57
  v_cvt_pk_bf16_f32 v23, v58, v59
  s_mul_i32 s48, s3, 1824
  s_add_u32 s48, s48, 114688
  v_lshrrev_b32 v9, 5, v0
  v_mul_u32_u24 v9, 912, v9
  v_and_b32 v10, 31, v0
  v_lshl_add_u32 v9, v10, 5, v9
  v_add_u32 v9, s48, v9
  s_mov_b64 exec, s[56:57]
  ds_write_b128 v9, v[16:19]
  ds_write_b128 v9, v[20:23] offset:16
  s_mov_b64 exec, -1
  v_and_b32 v9, 7, v0
  v_mul_u32_u24 v9, 912, v9
  v_lshl_add_u32 v9, v8, 4, v9
  v_add_u32 v9, 114688, v9
  v_lshrrev_b32 v10, 2, v7
  v_lshl_add_u32 v10, v8, 3, v10
  v_and_b32 v12, 3, v7
  v_lshlrev_b32 v12, 3, v12
  v_lshl_add_u32 v11, v10, 7, v12
  v_add_u32 v11, 125824, v11
  v_lshl_add_u32 v14, v10, 5, v12
  v_add_u32 v14, 125824, v14
  v_mul_u32_u24 v10, 896, v10
  v_add_u32 v10, v10, v12
  s_lshl_b32 s48, s3, 12
  s_add_u32 s48, s48, 125824
  v_lshlrev_b32 v13, 4, v0
  v_add_u32 v13, s48, v13
  s_waitcnt vmcnt(0)
  ds_write_b128 v13, v[64:67] offset:0
  ds_write_b128 v13, v[68:71] offset:1024
  ds_write_b128 v13, v[72:75] offset:2048
  ds_write_b128 v13, v[76:79] offset:3072
  v_mov_b32 v12, 125724
  v_mov_b32 v13, 1
  s_mov_b64 exec, 1
  s_waitcnt lgkmcnt(0)
  ds_add_u32 v12, v13
  s_mov_b64 exec, -1
  s_add_u32 s94, s94, 1
  s_cmp_eq_u32 s3, 0
  s_cbranch_scc1 L_svc
  s_setprio 2
  s_cmp_eq_u32 s3, 1
  s_cbranch_scc0 L_wostage
  s_cmp_eq_u32 s89, 0
  s_cbranch_scc1 L_ffn_done
  v_lshrrev_b32 v14, 3, v0
  v_and_b32 v13, 7, v0
  v_lshlrev_b32 v13, 4, v13
  v_mul_u32_u24 v12, s99, v14
  v_add_u32 v12, v12, v13
  v_lshlrev_b32 v14, 4, v0
  v_add_u32 v14, 125824, v14
  s_lshl_b32 s99, s99, 3
  s_mul_i32 s64, s99, 0
  s_mul_i32 s65, s99, 1
  s_mul_i32 s66, s99, 2
  s_mul_i32 s67, s99, 3
  s_mul_i32 s68, s99, 4
  s_mul_i32 s69, s99, 5
  s_mul_i32 s70, s99, 6
  s_mul_i32 s71, s99, 7
  s_mul_i32 s72, s99, 8
  s_mul_i32 s73, s99, 9
  s_mul_i32 s74, s99, 10
  s_mul_i32 s75, s99, 11
  s_mul_i32 s76, s99, 12
  s_mul_i32 s77, s99, 13
  s_mul_i32 s78, s99, 14
  s_mul_i32 s79, s99, 15
  s_mul_i32 s80, s99, 16
  s_mul_i32 s81, s99, 17
  s_mul_i32 s82, s99, 18
  s_mul_i32 s83, s99, 19
  buffer_load_dwordx4 v[96:99], v12, s[24:27], s64 offen nt
  buffer_load_dwordx4 v[100:103], v12, s[24:27], s65 offen nt
  buffer_load_dwordx4 v[104:107], v12, s[24:27], s66 offen nt
  buffer_load_dwordx4 v[108:111], v12, s[24:27], s67 offen nt
  buffer_load_dwordx4 v[112:115], v12, s[24:27], s68 offen nt
  buffer_load_dwordx4 v[116:119], v12, s[24:27], s69 offen nt
  buffer_load_dwordx4 v[120:123], v12, s[24:27], s70 offen nt
  buffer_load_dwordx4 v[124:127], v12, s[24:27], s71 offen nt
  buffer_load_dwordx4 v[128:131], v12, s[24:27], s72 offen nt
  buffer_load_dwordx4 v[132:135], v12, s[24:27], s73 offen nt
  buffer_load_dwordx4 v[136:139], v12, s[24:27], s74 offen nt
  buffer_load_dwordx4 v[140:143], v12, s[24:27], s75 offen nt
  buffer_load_dwordx4 v[144:147], v12, s[24:27], s76 offen nt
  buffer_load_dwordx4 v[148:151], v12, s[24:27], s77 offen nt
  buffer_load_dwordx4 v[152:155], v12, s[24:27], s78 offen nt
  buffer_load_dwordx4 v[156:159], v12, s[24:27], s79 offen nt
  buffer_load_dwordx4 v[160:163], v12, s[24:27], s80 offen nt
  buffer_load_dwordx4 v[164:167], v12, s[24:27], s81 offen nt
  buffer_load_dwordx4 v[168:171], v12, s[24:27], s82 offen nt
  buffer_load_dwordx4 v[172:175], v12, s[24:27], s83 offen nt
  s_mul_i32 s64, s99, 20
  s_mul_i32 s65, s99, 21
  s_mul_i32 s66, s99, 22
  s_mul_i32 s67, s99, 23
  s_mul_i32 s68, s99, 24
  s_mul_i32 s69, s99, 25
  s_mul_i32 s70, s99, 26
  s_mul_i32 s71, s99, 27
  s_mul_i32 s72, s99, 28
  s_mul_i32 s73, s99, 29
  s_mul_i32 s74, s99, 30
  s_mul_i32 s75, s99, 31
  s_mul_i32 s76, s99, 32
  s_mul_i32 s77, s99, 33
  s_mul_i32 s78, s99, 34
  s_mul_i32 s79, s99, 35
  s_mul_i32 s80, s99, 36
  s_mul_i32 s81, s99, 37
  s_mul_i32 s82, s99, 38
  s_mul_i32 s83, s99, 39
  buffer_load_dwordx4 v[176:179], v12, s[24:27], s64 offen nt
  buffer_load_dwordx4 v[180:183], v12, s[24:27], s65 offen nt
  buffer_load_dwordx4 v[184:187], v12, s[24:27], s66 offen nt
  buffer_load_dwordx4 v[188:191], v12, s[24:27], s67 offen nt
  buffer_load_dwordx4 v[192:195], v12, s[24:27], s68 offen nt
  buffer_load_dwordx4 v[196:199], v12, s[24:27], s69 offen nt
  buffer_load_dwordx4 v[200:203], v12, s[24:27], s70 offen nt
  buffer_load_dwordx4 v[204:207], v12, s[24:27], s71 offen nt
  buffer_load_dwordx4 v[208:211], v12, s[24:27], s72 offen nt
  buffer_load_dwordx4 v[212:215], v12, s[24:27], s73 offen nt
  buffer_load_dwordx4 v[216:219], v12, s[24:27], s74 offen nt
  buffer_load_dwordx4 v[220:223], v12, s[24:27], s75 offen nt
  buffer_load_dwordx4 v[224:227], v12, s[24:27], s76 offen nt
  buffer_load_dwordx4 v[228:231], v12, s[24:27], s77 offen nt
  buffer_load_dwordx4 v[232:235], v12, s[24:27], s78 offen nt
  buffer_load_dwordx4 v[236:239], v12, s[24:27], s79 offen nt
  buffer_load_dwordx4 v[240:243], v12, s[24:27], s80 offen nt
  buffer_load_dwordx4 v[244:247], v12, s[24:27], s81 offen nt
  buffer_load_dwordx4 v[248:251], v12, s[24:27], s82 offen nt
  buffer_load_dwordx4 v[252:255], v12, s[24:27], s83 offen nt
  s_cmp_eq_u32 s89, 2
  s_cbranch_scc0 L_ffn_act_ok
  v_mov_b32 v72, 125712
  s_mov_b32 s54, 0
L_lw_1:
  ds_read_b32 v73, v72
  s_add_u32 s54, s54, 1
  s_cmp_gt_u32 s54, 200000
  s_cbranch_scc1 L_lwx_2
  s_waitcnt lgkmcnt(0)
  v_cmp_le_u32 vcc, 22, v73
  s_cbranch_vccnz L_lwx_2
  s_sleep 16
  s_branch L_lw_1
L_lwx_2:
  s_waitcnt lgkmcnt(0)
  s_mul_i32 s48, s98, 1792
  s_add_u32 s48, s48, 524288
  s_add_u32 s64, s48, 0
  s_add_u32 s65, s48, 7168
  s_add_u32 s66, s48, 14336
  s_add_u32 s67, s48, 21504
  s_add_u32 s68, s48, 28672
  s_add_u32 s69, s48, 35840
  s_add_u32 s70, s48, 43008
  s_add_u32 s71, s48, 50176
  v_lshlrev_b32 v13, 4, v0
  s_mov_b32 s54, 0
  s_mov_b32 exec_hi, 0x00ffffff
L_hpoll:
  buffer_load_dwordx4 v[16:19], v13, s[36:39], s64 offen offset:0 sc1
  buffer_load_dwordx4 v[20:23], v13, s[36:39], s64 offen offset:896 sc1
  buffer_load_dwordx4 v[24:27], v13, s[36:39], s65 offen offset:0 sc1
  buffer_load_dwordx4 v[28:31], v13, s[36:39], s65 offen offset:896 sc1
  buffer_load_dwordx4 v[32:35], v13, s[36:39], s66 offen offset:0 sc1
  buffer_load_dwordx4 v[36:39], v13, s[36:39], s66 offen offset:896 sc1
  buffer_load_dwordx4 v[40:43], v13, s[36:39], s67 offen offset:0 sc1
  buffer_load_dwordx4 v[44:47], v13, s[36:39], s67 offen offset:896 sc1
  buffer_load_dwordx4 v[48:51], v13, s[36:39], s68 offen offset:0 sc1
  buffer_load_dwordx4 v[52:55], v13, s[36:39], s68 offen offset:896 sc1
  buffer_load_dwordx4 v[56:59], v13, s[36:39], s69 offen offset:0 sc1
  buffer_load_dwordx4 v[60:63], v13, s[36:39], s69 offen offset:896 sc1
  buffer_load_dwordx4 v[64:67], v13, s[36:39], s70 offen offset:0 sc1
  buffer_load_dwordx4 v[68:71], v13, s[36:39], s70 offen offset:896 sc1
  buffer_load_dwordx4 v[72:75], v13, s[36:39], s71 offen offset:0 sc1
  buffer_load_dwordx4 v[76:79], v13, s[36:39], s71 offen offset:896 sc1
  s_add_u32 s54, s54, 1
  s_cmp_gt_u32 s54, 200000
  s_cbranch_scc1 L_hpoll_x
  s_waitcnt vmcnt(0)
  v_cmp_ne_u64 s[56:57], s[94:95], v[18:19]
  v_cmp_ne_u64 vcc, s[94:95], v[22:23]
  s_or_b64 s[56:57], s[56:57], vcc
  v_cmp_ne_u64 vcc, s[94:95], v[26:27]
  s_or_b64 s[56:57], s[56:57], vcc
  v_cmp_ne_u64 vcc, s[94:95], v[30:31]
  s_or_b64 s[56:57], s[56:57], vcc
  v_cmp_ne_u64 vcc, s[94:95], v[34:35]
  s_or_b64 s[56:57], s[56:57], vcc
  v_cmp_ne_u64 vcc, s[94:95], v[38:39]
  s_or_b64 s[56:57], s[56:57], vcc
  v_cmp_ne_u64 vcc, s[94:95], v[42:43]
  s_or_b64 s[56:57], s[56:57], vcc
  v_cmp_ne_u64 vcc, s[94:95], v[46:47]
  s_or_b64 s[56:57], s[56:57], vcc
  v_cmp_ne_u64 vcc, s[94:95], v[50:51]
  s_or_b64 s[56:57], s[56:57], vcc
  v_cmp_ne_u64 vcc, s[94:95], v[54:55]
  s_or_b64 s[56:57], s[56:57], vcc
  v_cmp_ne_u64 vcc, s[94:95], v[58:59]
  s_or_b64 s[56:57], s[56:57], vcc
  v_cmp_ne_u64 vcc, s[94:95], v[62:63]
  s_or_b64 s[56:57], s[56:57], vcc
  v_cmp_ne_u64 vcc, s[94:95], v[66:67]
  s_or_b64 s[56:57], s[56:57], vcc
  v_cmp_ne_u64 vcc, s[94:95], v[70:71]
  s_or_b64 s[56:57], s[56:57], vcc
  v_cmp_ne_u64 vcc, s[94:95], v[74:75]
  s_or_b64 s[56:57], s[56:57], vcc
  v_cmp_ne_u64 vcc, s[94:95], v[78:79]
  s_or_b64 s[56:57], s[56:57], vcc
  s_and_b64 exec, exec, s[56:57]
  s_cbranch_execz L_hpoll_x
  s_sleep 16
  s_branch L_hpoll
L_hpoll_x:
  s_mov_b32 exec_lo, -1
  s_mov_b32 exec_hi, 0x00ffffff
  s_waitcnt vmcnt(0)
  v_lshlrev_b32 v13, 3, v0
  v_add_u32 v13, 142208, v13
  ds_write_b64 v13, v[16:17] offset:0
  ds_write_b64 v13, v[20:21] offset:448
  ds_write_b64 v13, v[24:25] offset:912
  ds_write_b64 v13, v[28:29] offset:1360
  ds_write_b64 v13, v[32:33] offset:1824
  ds_write_b64 v13, v[36:37] offset:2272
  ds_write_b64 v13, v[40:41] offset:2736
  ds_write_b64 v13, v[44:45] offset:3184
  s_waitcnt lgkmcnt(0)
  ds_write_b64 v13, v[48:49] offset:3648
  ds_write_b64 v13, v[52:53] offset:4096
  ds_write_b64 v13, v[56:57] offset:4560
  ds_write_b64 v13, v[60:61] offset:5008
  ds_write_b64 v13, v[64:65] offset:5472
  ds_write_b64 v13, v[68:69] offset:5920
  ds_write_b64 v13, v[72:73] offset:6384
  ds_write_b64 v13, v[76:77] offset:6832
  s_waitcnt lgkmcnt(0)
  s_mov_b64 exec, -1
  v_add_u32 v9, 27520, v9
L_ffn_act_ok:
  v_mov_b32 v72, 125700
  s_mov_b32 s54, 0
L_lw_3:
  ds_read_b32 v73, v72
  s_add_u32 s54, s54, 1
  s_cmp_gt_u32 s54, 200000
  s_cbranch_scc1 L_lwx_4
  s_waitcnt lgkmcnt(0)
  v_cmp_le_u32 vcc, 1, v73
  s_cbranch_vccnz L_lwx_4
  s_sleep 2
  s_branch L_lw_3
L_lwx_4:
  s_waitcnt lgkmcnt(0)
  s_waitcnt vmcnt(24)
  ds_write_b128 v14, v[96:99] offset:0
  ds_write_b128 v14, v[100:103] offset:1024
  ds_write_b128 v14, v[104:107] offset:2048
  ds_write_b128 v14, v[108:111] offset:3072
  ds_write_b128 v14, v[112:115] offset:4096
  ds_write_b128 v14, v[116:119] offset:5120
  ds_write_b128 v14, v[120:123] offset:6144
  ds_write_b128 v14, v[124:127] offset:7168
  s_waitcnt lgkmcnt(4)
  ds_write_b128 v14, v[128:131] offset:8192
  ds_write_b128 v14, v[132:135] offset:9216
  ds_write_b128 v14, v[136:139] offset:10240
  ds_write_b128 v14, v[140:143] offset:11264
  ds_write_b128 v14, v[144:147] offset:12288
  ds_write_b128 v14, v[148:151] offset:13312
  ds_write_b128 v14, v[152:155] offset:14336
  ds_write_b128 v14, v[156:159] offset:15360
  s_waitcnt lgkmcnt(4)
  s_waitcnt lgkmcnt(0)
  s_mul_i32 s64, s99, 40
  s_mul_i32 s65, s99, 41
  s_mul_i32 s66, s99, 42
  s_mul_i32 s67, s99, 43
  s_mul_i32 s68, s99, 44
  s_mul_i32 s69, s99, 45
  s_mul_i32 s70, s99, 46
  s_mul_i32 s71, s99, 47
  s_mul_i32 s72, s99, 48
  s_mul_i32 s73, s99, 49
  s_mul_i32 s74, s99, 50
  s_mul_i32 s75, s99, 51
  s_mul_i32 s76, s99, 52
  s_mul_i32 s77, s99, 53
  s_mul_i32 s78, s99, 54
  s_mul_i32 s79, s99, 55
  buffer_load_dwordx4 v[96:99], v12, s[24:27], s64 offen nt
  buffer_load_dwordx4 v[100:103], v12, s[24:27], s65 offen nt
  buffer_load_dwordx4 v[104:107], v12, s[24:27], s66 offen nt
  buffer_load_dwordx4 v[108:111], v12, s[24:27], s67 offen nt
  buffer_load_dwordx4 v[112:115], v12, s[24:27], s68 offen nt
  buffer_load_dwordx4 v[116:119], v12, s[24:27], s69 offen nt
  buffer_load_dwordx4 v[120:123], v12, s[24:27], s70 offen nt
  buffer_load_dwordx4 v[124:127], v12, s[24:27], s71 offen nt
  buffer_load_dwordx4 v[128:131], v12, s[24:27], s72 offen nt
  buffer_load_dwordx4 v[132:135], v12, s[24:27], s73 offen nt
  buffer_load_dwordx4 v[136:139], v12, s[24:27], s74 offen nt
  buffer_load_dwordx4 v[140:143], v12, s[24:27], s75 offen nt
  buffer_load_dwordx4 v[144:147], v12, s[24:27], s76 offen nt
  buffer_load_dwordx4 v[148:151], v12, s[24:27], s77 offen nt
  buffer_load_dwordx4 v[152:155], v12, s[24:27], s78 offen nt
  buffer_load_dwordx4 v[156:159], v12, s[24:27], s79 offen nt
  ds_read_b128 v[32:35], v9 offset:0
  ds_read_b64_tr_b16 v[36:37], v11 offset:0
  ds_read_b64_tr_b16 v[38:39], v11 offset:512
  ds_read_b64_tr_b16 v[40:41], v11 offset:32
  ds_read_b64_tr_b16 v[42:43], v11 offset:544
  ds_read_b64_tr_b16 v[44:45], v11 offset:64
  ds_read_b64_tr_b16 v[46:47], v11 offset:576
  ds_read_b64_tr_b16 v[48:49], v11 offset:96
  ds_read_b64_tr_b16 v[50:51], v11 offset:608
  s_waitcnt lgkmcnt(4)
  ds_read_b128 v[52:55], v9 offset:64
  ds_read_b64_tr_b16 v[56:57], v11 offset:4096
  ds_read_b64_tr_b16 v[58:59], v11 offset:4608
  ds_read_b64_tr_b16 v[60:61], v11 offset:4128
  ds_read_b64_tr_b16 v[62:63], v11 offset:4640
  ds_read_b64_tr_b16 v[64:65], v11 offset:4160
  ds_read_b64_tr_b16 v[66:67], v11 offset:4672
  ds_read_b64_tr_b16 v[68:69], v11 offset:4192
  ds_read_b64_tr_b16 v[70:71], v11 offset:4704
  s_waitcnt lgkmcnt(9)
  v_mfma_f32_16x16x32_bf16 v[16:19], v[36:39], v[32:35], 0
  v_mfma_f32_16x16x32_bf16 v[20:23], v[40:43], v[32:35], 0
  v_mfma_f32_16x16x32_bf16 v[24:27], v[44:47], v[32:35], 0
  v_mfma_f32_16x16x32_bf16 v[28:31], v[48:51], v[32:35], 0
  s_waitcnt lgkmcnt(4)
  ds_read_b128 v[32:35], v9 offset:128
  ds_read_b64_tr_b16 v[36:37], v11 offset:8192
  ds_read_b64_tr_b16 v[38:39], v11 offset:8704
  ds_read_b64_tr_b16 v[40:41], v11 offset:8224
  ds_read_b64_tr_b16 v[42:43], v11 offset:8736
  ds_read_b64_tr_b16 v[44:45], v11 offset:8256
  ds_read_b64_tr_b16 v[46:47], v11 offset:8768
  ds_read_b64_tr_b16 v[48:49], v11 offset:8288
  ds_read_b64_tr_b16 v[50:51], v11 offset:8800
  s_waitcnt lgkmcnt(9)
  v_mfma_f32_16x16x32_bf16 v[16:19], v[56:59], v[52:55], v[16:19]
  v_mfma_f32_16x16x32_bf16 v[20:23], v[60:63], v[52:55], v[20:23]
  v_mfma_f32_16x16x32_bf16 v[24:27], v[64:67], v[52:55], v[24:27]
  v_mfma_f32_16x16x32_bf16 v[28:31], v[68:71], v[52:55], v[28:31]
  s_waitcnt lgkmcnt(4)
  ds_read_b128 v[52:55], v9 offset:192
  ds_read_b64_tr_b16 v[56:57], v11 offset:12288
  ds_read_b64_tr_b16 v[58:59], v11 offset:12800
  ds_read_b64_tr_b16 v[60:61], v11 offset:12320
  ds_read_b64_tr_b16 v[62:63], v11 offset:12832
  ds_read_b64_tr_b16 v[64:65], v11 offset:12352
  ds_read_b64_tr_b16 v[66:67], v11 offset:12864
  ds_read_b64_tr_b16 v[68:69], v11 offset:12384
  ds_read_b64_tr_b16 v[70:71], v11 offset:12896
  s_waitcnt lgkmcnt(9)
  v_mfma_f32_16x16x32_bf16 v[16:19], v[36:39], v[32:35], v[16:19]
  v_mfma_f32_16x16x32_bf16 v[20:23], v[40:43], v[32:35], v[20:23]
  v_mfma_f32_16x16x32_bf16 v[24:27], v[44:47], v[32:35], v[24:27]
  v_mfma_f32_16x16x32_bf16 v[28:31], v[48:51], v[32:35], v[28:31]
  s_waitcnt lgkmcnt(0)
  v_mfma_f32_16x16x32_bf16 v[16:19], v[56:59], v[52:55], v[16:19]
  v_mfma_f32_16x16x32_bf16 v[20:23], v[60:63], v[52:55], v[20:23]
  v_mfma_f32_16x16x32_bf16 v[24:27], v[64:67], v[52:55], v[24:27]
  v_mfma_f32_16x16x32_bf16 v[28:31], v[68:71], v[52:55], v[28:31]
  s_waitcnt vmcnt(24)
  ds_write_b128 v14, v[160:163] offset:0
  ds_write_b128 v14, v[164:167] offset:1024
  ds_write_b128 v14, v[168:171] offset:2048
  ds_write_b128 v14, v[172:175] offset:3072
  ds_write_b128 v14, v[176:179] offset:4096
  ds_write_b128 v14, v[180:183] offset:5120
  ds_write_b128 v14, v[184:187] offset:6144
  ds_write_b128 v14, v[188:191] offset:7168
  s_waitcnt lgkmcnt(4)
  ds_write_b128 v14, v[192:195] offset:8192
  ds_write_b128 v14, v[196:199] offset:9216
  ds_write_b128 v14, v[200:203] offset:10240
  ds_write_b128 v14, v[204:207] offset:11264
  ds_write_b128 v14, v[208:211] offset:12288
  ds_write_b128 v14, v[212:215] offset:13312
  ds_write_b128 v14, v[216:219] offset:14336
  ds_write_b128 v14, v[220:223] offset:15360
  s_waitcnt lgkmcnt(4)
  s_waitcnt lgkmcnt(0)
  ds_read_b128 v[32:35], v9 offset:256
  ds_read_b64_tr_b16 v[36:37], v11 offset:0
  ds_read_b64_tr_b16 v[38:39], v11 offset:512
  ds_read_b64_tr_b16 v[40:41], v11 offset:32
  ds_read_b64_tr_b16 v[42:43], v11 offset:544
  ds_read_b64_tr_b16 v[44:45], v11 offset:64
  ds_read_b64_tr_b16 v[46:47], v11 offset:576
  ds_read_b64_tr_b16 v[48:49], v11 offset:96
  ds_read_b64_tr_b16 v[50:51], v11 offset:608
  s_waitcnt lgkmcnt(4)
  ds_read_b128 v[52:55], v9 offset:320
  ds_read_b64_tr_b16 v[56:57], v11 offset:4096
  ds_read_b64_tr_b16 v[58:59], v11 offset:4608
  ds_read_b64_tr_b16 v[60:61], v11 offset:4128
  ds_read_b64_tr_b16 v[62:63], v11 offset:4640
  ds_read_b64_tr_b16 v[64:65], v11 offset:4160
  ds_read_b64_tr_b16 v[66:67], v11 offset:4672
  ds_read_b64_tr_b16 v[68:69], v11 offset:4192
  ds_read_b64_tr_b16 v[70:71], v11 offset:4704
  s_waitcnt lgkmcnt(9)
  v_mfma_f32_16x16x32_bf16 v[16:19], v[36:39], v[32:35], v[16:19]
  v_mfma_f32_16x16x32_bf16 v[20:23], v[40:43], v[32:35], v[20:23]
  v_mfma_f32_16x16x32_bf16 v[24:27], v[44:47], v[32:35], v[24:27]
  v_mfma_f32_16x16x32_bf16 v[28:31], v[48:51], v[32:35], v[28:31]
  s_waitcnt lgkmcnt(4)
  ds_read_b128 v[32:35], v9 offset:384
  ds_read_b64_tr_b16 v[36:37], v11 offset:8192
  ds_read_b64_tr_b16 v[38:39], v11 offset:8704
  ds_read_b64_tr_b16 v[40:41], v11 offset:8224
  ds_read_b64_tr_b16 v[42:43], v11 offset:8736
  ds_read_b64_tr_b16 v[44:45], v11 offset:8256
  ds_read_b64_tr_b16 v[46:47], v11 offset:8768
  ds_read_b64_tr_b16 v[48:49], v11 offset:8288
  ds_read_b64_tr_b16 v[50:51], v11 offset:8800
  s_waitcnt lgkmcnt(9)
  v_mfma_f32_16x16x32_bf16 v[16:19], v[56:59], v[52:55], v[16:19]
  v_mfma_f32_16x16x32_bf16 v[20:23], v[60:63], v[52:55], v[20:23]
  v_mfma_f32_16x16x32_bf16 v[24:27], v[64:67], v[52:55], v[24:27]
  v_mfma_f32_16x16x32_bf16 v[28:31], v[68:71], v[52:55], v[28:31]
  s_waitcnt lgkmcnt(4)
  ds_read_b128 v[52:55], v9 offset:448
  ds_read_b64_tr_b16 v[56:57], v11 offset:12288
  ds_read_b64_tr_b16 v[58:59], v11 offset:12800
  ds_read_b64_tr_b16 v[60:61], v11 offset:12320
  ds_read_b64_tr_b16 v[62:63], v11 offset:12832
  ds_read_b64_tr_b16 v[64:65], v11 offset:12352
  ds_read_b64_tr_b16 v[66:67], v11 offset:12864
  ds_read_b64_tr_b16 v[68:69], v11 offset:12384
  ds_read_b64_tr_b16 v[70:71], v11 offset:12896
  s_waitcnt lgkmcnt(9)
  v_mfma_f32_16x16x32_bf16 v[16:19], v[36:39], v[32:35], v[16:19]
  v_mfma_f32_16x16x32_bf16 v[20:23], v[40:43], v[32:35], v[20:23]
  v_mfma_f32_16x16x32_bf16 v[24:27], v[44:47], v[32:35], v[24:27]
  v_mfma_f32_16x16x32_bf16 v[28:31], v[48:51], v[32:35], v[28:31]
  s_waitcnt lgkmcnt(0)
  v_mfma_f32_16x16x32_bf16 v[16:19], v[56:59], v[52:55], v[16:19]
  v_mfma_f32_16x16x32_bf16 v[20:23], v[60:63], v[52:55], v[20:23]
  v_mfma_f32_16x16x32_bf16 v[24:27], v[64:67], v[52:55], v[24:27]
  v_mfma_f32_16x16x32_bf16 v[28:31], v[68:71], v[52:55], v[28:31]
  s_waitcnt vmcnt(8)
  ds_write_b128 v14, v[224:227] offset:0
  ds_write_b128 v14, v[228:231] offset:1024
  ds_write_b128 v14, v[232:235] offset:2048
  ds_write_b128 v14, v[236:239] offset:3072
  ds_write_b128 v14, v[240:243] offset:4096
  ds_write_b128 v14, v[244:247] offset:5120
  ds_write_b128 v14, v[248:251] offset:6144
  ds_write_b128 v14, v[252:255] offset:7168
  s_waitcnt lgkmcnt(4)
  ds_write_b128 v14, v[96:99] offset:8192
  ds_write_b128 v14, v[100:103] offset:9216
  ds_write_b128 v14, v[104:107] offset:10240
  ds_write_b128 v14, v[108:111] offset:11264
  ds_write_b128 v14, v[112:115] offset:12288
  ds_write_b128 v14, v[116:119] offset:13312
  ds_write_b128 v14, v[120:123] offset:14336
  ds_write_b128 v14, v[124:127] offset:15360
  s_waitcnt lgkmcnt(4)
  s_waitcnt lgkmcnt(0)
  ds_read_b128 v[32:35], v9 offset:512
  ds_read_b64_tr_b16 v[36:37], v11 offset:0
  ds_read_b64_tr_b16 v[38:39], v11 offset:512
  ds_read_b64_tr_b16 v[40:41], v11 offset:32
  ds_read_b64_tr_b16 v[42:43], v11 offset:544
  ds_read_b64_tr_b16 v[44:45], v11 offset:64
  ds_read_b64_tr_b16 v[46:47], v11 offset:576
  ds_read_b64_tr_b16 v[48:49], v11 offset:96
  ds_read_b64_tr_b16 v[50:51], v11 offset:608
  s_waitcnt lgkmcnt(4)
  ds_read_b128 v[52:55], v9 offset:576
  ds_read_b64_tr_b16 v[56:57], v11 offset:4096
  ds_read_b64_tr_b16 v[58:59], v11 offset:4608
  ds_read_b64_tr_b16 v[60:61], v11 offset:4128
  ds_read_b64_tr_b16 v[62:63], v11 offset:4640
  ds_read_b64_tr_b16 v[64:65], v11 offset:4160
  ds_read_b64_tr_b16 v[66:67], v11 offset:4672
  ds_read_b64_tr_b16 v[68:69], v11 offset:4192
  ds_read_b64_tr_b16 v[70:71], v11 offset:4704
  s_waitcnt lgkmcnt(9)
  v_mfma_f32_16x16x32_bf16 v[16:19], v[36:39], v[32:35], v[16:19]
  v_mfma_f32_16x16x32_bf16 v[20:23], v[40:43], v[32:35], v[20:23]
  v_mfma_f32_16x16x32_bf16 v[24:27], v[44:47], v[32:35], v[24:27]
  v_mfma_f32_16x16x32_bf16 v[28:31], v[48:51], v[32:35], v[28:31]
  s_waitcnt lgkmcnt(4)
  ds_read_b128 v[32:35], v9 offset:640
  ds_read_b64_tr_b16 v[36:37], v11 offset:8192
  ds_read_b64_tr_b16 v[38:39], v11 offset:8704
  ds_read_b64_tr_b16 v[40:41], v11 offset:8224
  ds_read_b64_tr_b16 v[42:43], v11 offset:8736
  ds_read_b64_tr_b16 v[44:45], v11 offset:8256
  ds_read_b64_tr_b16 v[46:47], v11 offset:8768
  ds_read_b64_tr_b16 v[48:49], v11 offset:8288
  ds_read_b64_tr_b16 v[50:51], v11 offset:8800
  s_waitcnt lgkmcnt(9)
  v_mfma_f32_16x16x32_bf16 v[16:19], v[56:59], v[52:55], v[16:19]
  v_mfma_f32_16x16x32_bf16 v[20:23], v[60:63], v[52:55], v[20:23]
  v_mfma_f32_16x16x32_bf16 v[24:27], v[64:67], v[52:55], v[24:27]
  v_mfma_f32_16x16x32_bf16 v[28:31], v[68:71], v[52:55], v[28:31]
  s_waitcnt lgkmcnt(4)
  ds_read_b128 v[52:55], v9 offset:704
  ds_read_b64_tr_b16 v[56:57], v11 offset:12288
  ds_read_b64_tr_b16 v[58:59], v11 offset:12800
  ds_read_b64_tr_b16 v[60:61], v11 offset:12320
  ds_read_b64_tr_b16 v[62:63], v11 offset:12832
  ds_read_b64_tr_b16 v[64:65], v11 offset:12352
  ds_read_b64_tr_b16 v[66:67], v11 offset:12864
  ds_read_b64_tr_b16 v[68:69], v11 offset:12384
  ds_read_b64_tr_b16 v[70:71], v11 offset:12896
  s_waitcnt lgkmcnt(9)
  v_mfma_f32_16x16x32_bf16 v[16:19], v[36:39], v[32:35], v[16:19]
  v_mfma_f32_16x16x32_bf16 v[20:23], v[40:43], v[32:35], v[20:23]
  v_mfma_f32_16x16x32_bf16 v[24:27], v[44:47], v[32:35], v[24:27]
  v_mfma_f32_16x16x32_bf16 v[28:31], v[48:51], v[32:35], v[28:31]
  s_waitcnt lgkmcnt(0)
  v_mfma_f32_16x16x32_bf16 v[16:19], v[56:59], v[52:55], v[16:19]
  v_mfma_f32_16x16x32_bf16 v[20:23], v[60:63], v[52:55], v[20:23]
  v_mfma_f32_16x16x32_bf16 v[24:27], v[64:67], v[52:55], v[24:27]
  v_mfma_f32_16x16x32_bf16 v[28:31], v[68:71], v[52:55], v[28:31]
  s_waitcnt vmcnt(0)
  ds_write_b128 v14, v[128:131] offset:0
  ds_write_b128 v14, v[132:135] offset:1024
  ds_write_b128 v14, v[136:139] offset:2048
  ds_write_b128 v14, v[140:143] offset:3072
  ds_write_b128 v14, v[144:147] offset:4096
  ds_write_b128 v14, v[148:151] offset:5120
  ds_write_b128 v14, v[152:155] offset:6144
  ds_write_b128 v14, v[156:159] offset:7168
  s_waitcnt lgkmcnt(4)
  s_waitcnt lgkmcnt(0)
  ds_read_b128 v[32:35], v9 offset:768
  ds_read_b64_tr_b16 v[36:37], v11 offset:0
  ds_read_b64_tr_b16 v[38:39], v11 offset:512
  ds_read_b64_tr_b16 v[40:41], v11 offset:32
  ds_read_b64_tr_b16 v[42:43], v11 offset:544
  ds_read_b64_tr_b16 v[44:45], v11 offset:64
  ds_read_b64_tr_b16 v[46:47], v11 offset:576
  ds_read_b64_tr_b16 v[48:49], v11 offset:96
  ds_read_b64_tr_b16 v[50:51], v11 offset:608
  s_waitcnt lgkmcnt(4)
  ds_read_b128 v[52:55], v9 offset:832
  ds_read_b64_tr_b16 v[56:57], v11 offset:4096
  ds_read_b64_tr_b16 v[58:59], v11 offset:4608
  ds_read_b64_tr_b16 v[60:61], v11 offset:4128
  ds_read_b64_tr_b16 v[62:63], v11 offset:4640
  ds_read_b64_tr_b16 v[64:65], v11 offset:4160
  ds_read_b64_tr_b16 v[66:67], v11 offset:4672
  ds_read_b64_tr_b16 v[68:69], v11 offset:4192
  ds_read_b64_tr_b16 v[70:71], v11 offset:4704
  s_waitcnt lgkmcnt(9)
  v_mfma_f32_16x16x32_bf16 v[16:19], v[36:39], v[32:35], v[16:19]
  v_mfma_f32_16x16x32_bf16 v[20:23], v[40:43], v[32:35], v[20:23]
  v_mfma_f32_16x16x32_bf16 v[24:27], v[44:47], v[32:35], v[24:27]
  v_mfma_f32_16x16x32_bf16 v[28:31], v[48:51], v[32:35], v[28:31]
  s_waitcnt lgkmcnt(0)
  v_mfma_f32_16x16x32_bf16 v[16:19], v[56:59], v[52:55], v[16:19]
  v_mfma_f32_16x16x32_bf16 v[20:23], v[60:63], v[52:55], v[20:23]
  v_mfma_f32_16x16x32_bf16 v[24:27], v[64:67], v[52:55], v[24:27]
  v_mfma_f32_16x16x32_bf16 v[28:31], v[68:71], v[52:55], v[28:31]
  v_mov_b32 v92, s94
  v_mov_b32 v93, s95
  v_and_b32 v12, 7, v0
  v_bfe_u32 v13, v0, 3, 1
  s_mov_b32 s58, 0xff00ff00
  s_mov_b32 s59, 0xff00ff00
  s_cmp_eq_u32 s89, 2
  s_cbranch_scc1 L_ffn_out2
  v_mul_u32_u24 v12, 7168, v12
  v_lshl_add_u32 v12, v8, 4, v12
  v_lshl_add_u32 v12, v13, 6, v12
  s_lshl_b32 s52, s87, 8
  s_add_u32 s52, s52, 524288
  v_max_f32 v16, 0, v16
  v_max_f32 v17, 0, v17
  v_max_f32 v18, 0, v18
  v_max_f32 v19, 0, v19
  v_cvt_pk_bf16_f32 v16, v16, v17
  v_cvt_pk_bf16_f32 v17, v18, v19
  v_max_f32 v20, 0, v20
  v_max_f32 v21, 0, v21
  v_max_f32 v22, 0, v22
  v_max_f32 v23, 0, v23
  v_cvt_pk_bf16_f32 v20, v20, v21
  v_cvt_pk_bf16_f32 v21, v22, v23
  v_max_f32 v24, 0, v24
  v_max_f32 v25, 0, v25
  v_max_f32 v26, 0, v26
  v_max_f32 v27, 0, v27
  v_cvt_pk_bf16_f32 v24, v24, v25
  v_cvt_pk_bf16_f32 v25, v26, v27
  v_max_f32 v28, 0, v28
  v_max_f32 v29, 0, v29
  v_max_f32 v30, 0, v30
  v_max_f32 v31, 0, v31
  v_cvt_pk_bf16_f32 v28, v28, v29
  v_cvt_pk_bf16_f32 v29, v30, v31
  v_cndmask_b32 v96, v16, v20, s[58:59]
  v_cndmask_b32 v97, v17, v21, s[58:59]
  v_mov_b32 v98, v92
  v_mov_b32 v99, v93
  v_cndmask_b32 v100, v24, v28, s[58:59]
  v_cndmask_b32 v101, v25, v29, s[58:59]
  v_mov_b32 v102, v92
  v_mov_b32 v103, v93
  buffer_store_dwordx4 v[96:99], v12, s[36:39], s52 offen offset:0 sc1
  buffer_store_dwordx4 v[100:103], v12, s[36:39], s52 offen offset:128 sc1
  s_branch L_ffn_done
L_ffn_out2:
  v_mul_u32_u24 v12, 3584, v12
  v_lshl_add_u32 v12, v8, 5, v12
  v_lshl_add_u32 v12, v13, 4, v12
  s_mul_i32 s52, s98, 28672
  s_lshl_b32 s48, s88, 9
  s_add_u32 s52, s52, s48
  s_add_u32 s52, s52, 262144
  v_cndmask_b32 v96, v92, v18, s[58:59]
  v_cndmask_b32 v97, v93, v19, s[58:59]
  v_cndmask_b32 v98, v16, v92, s[58:59]
  v_cndmask_b32 v99, v17, v93, s[58:59]
  v_cndmask_b32 v100, v92, v22, s[58:59]
  v_cndmask_b32 v101, v93, v23, s[58:59]
  v_cndmask_b32 v102, v20, v92, s[58:59]
  v_cndmask_b32 v103, v21, v93, s[58:59]
  v_cndmask_b32 v104, v92, v26, s[58:59]
  v_cndmask_b32 v105, v93, v27, s[58:59]
  v_cndmask_b32 v106, v24, v92, s[58:59]
  v_cndmask_b32 v107, v25, v93, s[58:59]
  v_cndmask_b32 v108, v92, v30, s[58:59]
  v_cndmask_b32 v109, v93, v31, s[58:59]
  v_cndmask_b32 v110, v28, v92, s[58:59]
  v_cndmask_b32 v111, v29, v93, s[58:59]
  buffer_store_dwordx4 v[96:99], v12, s[36:39], s52 offen offset:0 sc1
  buffer_store_dwordx4 v[100:103], v12, s[36:39], s52 offen offset:128 sc1
  buffer_store_dwordx4 v[104:107], v12, s[36:39], s52 offen offset:256 sc1
  buffer_store_dwordx4 v[108:111], v12, s[36:39], s52 offen offset:384 sc1
L_ffn_done:
  v_mov_b32 v12, 125720
  v_mov_b32 v13, 1
  s_waitcnt lgkmcnt(0)
  ds_write_b32 v12, v13
  s_branch L_helper_end
L_svc:
  v_mov_b32 v12, 125724
  s_mov_b32 s54, 0
L_lw_5:
  ds_read_b32 v13, v12
  s_add_u32 s54, s54, 1
  s_cmp_gt_u32 s54, 200000
  s_cbranch_scc1 L_lwx_6
  s_waitcnt lgkmcnt(0)
  v_cmp_le_u32 vcc, 4, v13
  s_cbranch_vccnz L_lwx_6
  s_branch L_lw_5
L_lwx_6:
  s_waitcnt lgkmcnt(0)
  ds_read_b128 v[24:27], v9 offset:0
  ds_read_b64_tr_b16 v[28:29], v14 offset:0
  ds_read_b64_tr_b16 v[30:31], v14 offset:128
  ds_read_b128 v[32:35], v9 offset:64
  ds_read_b64_tr_b16 v[36:37], v14 offset:1024
  ds_read_b64_tr_b16 v[38:39], v14 offset:1152
  ds_read_b128 v[40:43], v9 offset:128
  ds_read_b64_tr_b16 v[44:45], v14 offset:2048
  ds_read_b64_tr_b16 v[46:47], v14 offset:2176
  ds_read_b128 v[48:51], v9 offset:192
  ds_read_b64_tr_b16 v[52:53], v14 offset:3072
  ds_read_b64_tr_b16 v[54:55], v14 offset:3200
  s_waitcnt lgkmcnt(9)
  v_mfma_f32_16x16x32_bf16 v[16:19], v[28:31], v[24:27], 0
  ds_read_b128 v[56:59], v9 offset:256
  ds_read_b64_tr_b16 v[60:61], v14 offset:4096
  ds_read_b64_tr_b16 v[62:63], v14 offset:4224
  s_waitcnt lgkmcnt(9)
  v_mfma_f32_16x16x32_bf16 v[16:19], v[36:39], v[32:35], v[16:19]
  ds_read_b128 v[24:27], v9 offset:320
  ds_read_b64_tr_b16 v[28:29], v14 offset:5120
  ds_read_b64_tr_b16 v[30:31], v14 offset:5248
  s_waitcnt lgkmcnt(9)
  v_mfma_f32_16x16x32_bf16 v[16:19], v[44:47], v[40:43], v[16:19]
  ds_read_b128 v[32:35], v9 offset:384
  ds_read_b64_tr_b16 v[36:37], v14 offset:6144
  ds_read_b64_tr_b16 v[38:39], v14 offset:6272
  s_waitcnt lgkmcnt(9)
  v_mfma_f32_16x16x32_bf16 v[16:19], v[52:55], v[48:51], v[16:19]
  ds_read_b128 v[40:43], v9 offset:448
  ds_read_b64_tr_b16 v[44:45], v14 offset:7168
  ds_read_b64_tr_b16 v[46:47], v14 offset:7296
  s_waitcnt lgkmcnt(9)
  v_mfma_f32_16x16x32_bf16 v[16:19], v[60:63], v[56:59], v[16:19]
  ds_read_b128 v[48:51], v9 offset:512
  ds_read_b64_tr_b16 v[52:53], v14 offset:8192
  ds_read_b64_tr_b16 v[54:55], v14 offset:8320
  s_waitcnt lgkmcnt(9)
  v_mfma_f32_16x16x32_bf16 v[16:19], v[28:31], v[24:27], v[16:19]
  ds_read_b128 v[56:59], v9 offset:576
  ds_read_b64_tr_b16 v[60:61], v14 offset:9216
  ds_read_b64_tr_b16 v[62:63], v14 offset:9344
  s_waitcnt lgkmcnt(9)
  v_mfma_f32_16x16x32_bf16 v[16:19], v[36:39], v[32:35], v[16:19]
  ds_read_b128 v[24:27], v9 offset:640
  ds_read_b64_tr_b16 v[28:29], v14 offset:10240
  ds_read_b64_tr_b16 v[30:31], v14 offset:10368
  s_waitcnt lgkmcnt(9)
  v_mfma_f32_16x16x32_bf16 v[16:19], v[44:47], v[40:43], v[16:19]
  ds_read_b128 v[32:35], v9 offset:704
  ds_read_b64_tr_b16 v[36:37], v14 offset:11264
  ds_read_b64_tr_b16 v[38:39], v14 offset:11392
  s_waitcnt lgkmcnt(9)
  v_mfma_f32_16x16x32_bf16 v[16:19], v[52:55], v[48:51], v[16:19]
  ds_read_b128 v[40:43], v9 offset:768
  ds_read_b64_tr_b16 v[44:45], v14 offset:12288
  ds_read_b64_tr_b16 v[46:47], v14 offset:12416
  s_waitcnt lgkmcnt(9)
  v_mfma_f32_16x16x32_bf16 v[16:19], v[60:63], v[56:59], v[16:19]
  ds_read_b128 v[48:51], v9 offset:832
  ds_read_b64_tr_b16 v[52:53], v14 offset:13312
  ds_read_b64_tr_b16 v[54:55], v14 offset:13440
  s_waitcnt lgkmcnt(9)
  v_mfma_f32_16x16x32_bf16 v[16:19], v[28:31], v[24:27], v[16:19]
  s_waitcnt lgkmcnt(6)
  v_mfma_f32_16x16x32_bf16 v[16:19], v[36:39], v[32:35], v[16:19]
  s_waitcnt lgkmcnt(3)
  v_mfma_f32_16x16x32_bf16 v[16:19], v[44:47], v[40:43], v[16:19]
  s_waitcnt lgkmcnt(0)
  v_mfma_f32_16x16x32_bf16 v[16:19], v[52:55], v[48:51], v[16:19]
  v_lshlrev_b32 v12, 14, v7
  v_lshl_add_u32 v12, v8, 4, v12
  s_lshl_b32 s52, s86, 6
  s_add_u32 s52, s52, 4096
  s_nop 3
  v_cvt_pk_bf16_f32 v16, v16, v17
  v_cvt_pk_bf16_f32 v17, v18, v19
  v_mov_b32 v18, s94
  v_mov_b32 v19, s95
  s_mov_b32 exec_lo, 0x00ff00ff
  s_mov_b32 exec_hi, 0x00ff00ff
  buffer_store_dwordx4 v[16:19], v12, s[36:39], s52 offen sc1
  s_mov_b64 exec, -1
  v_mov_b32 v20, 125700
  v_mov_b32 v21, 1
  s_waitcnt lgkmcnt(0)
  ds_write_b32 v20, v21
  s_lshl_b32 s52, s6, 14
  s_lshl_b32 s48, s4, 11
  s_add_u32 s52, s52, s48
  s_add_u32 s52, s52, 4096
  v_lshlrev_b32 v12, 4, v0
  s_mov_b32 s54, 0
L_qpoll:
  s_sleep 64
  buffer_load_dwordx4 v[24:27], v12, s[36:39], s52 offen sc1
  buffer_load_dwordx4 v[28:31], v12, s[36:39], s52 offen offset:1024 sc1
  s_add_u32 s54, s54, 1
  s_cmp_gt_u32 s54, 200000
  s_cbranch_scc1 L_qpoll_x
  s_waitcnt vmcnt(0)
  v_cmp_ne_u64 vcc, s[94:95], v[26:27]
  v_cmp_ne_u64 s[56:57], s[94:95], v[30:31]
  s_or_b64 vcc, vcc, s[56:57]
  s_and_b64 exec, exec, vcc
  s_cbranch_execnz L_qpoll
L_qpoll_x:
  s_mov_b64 exec, -1
  s_waitcnt vmcnt(0)
  v_lshlrev_b32 v12, 3, v0
  v_add_u32 v12, 121984, v12
  ds_write_b64 v12, v[24:25]
  ds_write_b64 v12, v[28:29] offset:512
  v_mov_b32 v12, 125696
  v_mov_b32 v13, 1
  s_waitcnt lgkmcnt(0)
  ds_write_b32 v12, v13
  s_branch L_helper_end
L_wostage:
  s_cmp_eq_u32 s3, 2
  s_cbranch_scc0 L_nogc
  s_cmp_eq_u32 s7, 0
  s_cbranch_scc0 L_nogc
  v_mov_b32 v16, 0
  v_mov_b32 v17, 0
  v_mov_b32 v18, s94
  v_mov_b32 v19, s95
  s_lshl_b32 s52, s87, 7
  s_add_u32 s52, s52, 2686976
  s_mov_b64 exec, 1
  buffer_store_dwordx4 v[16:19], v16, s[36:39], s52 offen sc1
  s_mov_b64 exec, -1
L_nogc:
  s_sub_u32 s48, s3, 2
  s_mul_i32 s49, s48, 57344
  s_mul_i32 s48, s48, 229376
  v_lshlrev_b32 v12, 4, v0
  v_add_u32 v13, s49, v12
  s_add_u32 s64, s48, 0
  s_add_u32 s65, s48, 4096
  s_add_u32 s66, s48, 8192
  s_add_u32 s67, s48, 12288
  s_add_u32 s68, s48, 16384
  s_add_u32 s69, s48, 20480
  s_add_u32 s70, s48, 24576
  s_add_u32 s71, s48, 28672
  s_add_u32 s72, s48, 32768
  s_add_u32 s73, s48, 36864
  s_add_u32 s74, s48, 40960
  s_add_u32 s75, s48, 45056
  s_add_u32 s76, s48, 49152
  s_add_u32 s77, s48, 53248
  buffer_load_dwordx4 v[32:35], v12, s[32:35], s64 offen offset:0 nt
  buffer_load_dwordx4 v[36:39], v12, s[32:35], s64 offen offset:1024 nt
  buffer_load_dwordx4 v[40:43], v12, s[32:35], s64 offen offset:2048 nt
  buffer_load_dwordx4 v[44:47], v12, s[32:35], s64 offen offset:3072 nt
  buffer_load_dwordx4 v[48:51], v12, s[32:35], s65 offen offset:0 nt
  buffer_load_dwordx4 v[52:55], v12, s[32:35], s65 offen offset:1024 nt
  buffer_load_dwordx4 v[56:59], v12, s[32:35], s65 offen offset:2048 nt
  buffer_load_dwordx4 v[60:63], v12, s[32:35], s65 offen offset:3072 nt
  buffer_load_dwordx4 v[64:67], v12, s[32:35], s66 offen offset:0 nt
  buffer_load_dwordx4 v[68:71], v12, s[32:35], s66 offen offset:1024 nt
  buffer_load_dwordx4 v[72:75], v12, s[32:35], s66 offen offset:2048 nt
  buffer_load_dwordx4 v[76:79], v12, s[32:35], s66 offen offset:3072 nt
  buffer_load_dwordx4 v[80:83], v12, s[32:35], s67 offen offset:0 nt
  buffer_load_dwordx4 v[84:87], v12, s[32:35], s67 offen offset:1024 nt
  s_nop 0
  buffer_load_dwordx4 v[88:91], v12, s[32:35], s67 offen offset:2048 nt
  buffer_load_dwordx4 v[92:95], v12, s[32:35], s67 offen offset:3072 nt
  buffer_load_dwordx4 v[96:99], v12, s[32:35], s68 offen offset:0 nt
  buffer_load_dwordx4 v[100:103], v12, s[32:35], s68 offen offset:1024 nt
  buffer_load_dwordx4 v[104:107], v12, s[32:35], s68 offen offset:2048 nt
  buffer_load_dwordx4 v[108:111], v12, s[32:35], s68 offen offset:3072 nt
  buffer_load_dwordx4 v[112:115], v12, s[32:35], s69 offen offset:0 nt
  buffer_load_dwordx4 v[116:119], v12, s[32:35], s69 offen offset:1024 nt
  buffer_load_dwordx4 v[120:123], v12, s[32:35], s69 offen offset:2048 nt
  buffer_load_dwordx4 v[124:127], v12, s[32:35], s69 offen offset:3072 nt
  buffer_load_dwordx4 v[128:131], v12, s[32:35], s70 offen offset:0 nt
  buffer_load_dwordx4 v[132:135], v12, s[32:35], s70 offen offset:1024 nt
  buffer_load_dwordx4 v[136:139], v12, s[32:35], s70 offen offset:2048 nt
  buffer_load_dwordx4 v[140:143], v12, s[32:35], s70 offen offset:3072 nt
  s_nop 0
  buffer_load_dwordx4 v[144:147], v12, s[32:35], s71 offen offset:0 nt
  buffer_load_dwordx4 v[148:151], v12, s[32:35], s71 offen offset:1024 nt
  buffer_load_dwordx4 v[152:155], v12, s[32:35], s71 offen offset:2048 nt
  buffer_load_dwordx4 v[156:159], v12, s[32:35], s71 offen offset:3072 nt
  buffer_load_dwordx4 v[160:163], v12, s[32:35], s72 offen offset:0 nt
  buffer_load_dwordx4 v[164:167], v12, s[32:35], s72 offen offset:1024 nt
  buffer_load_dwordx4 v[168:171], v12, s[32:35], s72 offen offset:2048 nt
  buffer_load_dwordx4 v[172:175], v12, s[32:35], s72 offen offset:3072 nt
  buffer_load_dwordx4 v[176:179], v12, s[32:35], s73 offen offset:0 nt
  buffer_load_dwordx4 v[180:183], v12, s[32:35], s73 offen offset:1024 nt
  buffer_load_dwordx4 v[184:187], v12, s[32:35], s73 offen offset:2048 nt
  buffer_load_dwordx4 v[188:191], v12, s[32:35], s73 offen offset:3072 nt
  buffer_load_dwordx4 v[192:195], v12, s[32:35], s74 offen offset:0 nt
  buffer_load_dwordx4 v[196:199], v12, s[32:35], s74 offen offset:1024 nt
  s_nop 0
  buffer_load_dwordx4 v[200:203], v12, s[32:35], s74 offen offset:2048 nt
  buffer_load_dwordx4 v[204:207], v12, s[32:35], s74 offen offset:3072 nt
  buffer_load_dwordx4 v[208:211], v12, s[32:35], s75 offen offset:0 nt
  buffer_load_dwordx4 v[212:215], v12, s[32:35], s75 offen offset:1024 nt
  buffer_load_dwordx4 v[216:219], v12, s[32:35], s75 offen offset:2048 nt
  buffer_load_dwordx4 v[220:223], v12, s[32:35], s75 offen offset:3072 nt
  buffer_load_dwordx4 v[224:227], v12, s[32:35], s76 offen offset:0 nt
  buffer_load_dwordx4 v[228:231], v12, s[32:35], s76 offen offset:1024 nt
  buffer_load_dwordx4 v[232:235], v12, s[32:35], s76 offen offset:2048 nt
  buffer_load_dwordx4 v[236:239], v12, s[32:35], s76 offen offset:3072 nt
  buffer_load_dwordx4 v[240:243], v12, s[32:35], s77 offen offset:0 nt
  buffer_load_dwordx4 v[244:247], v12, s[32:35], s77 offen offset:1024 nt
  buffer_load_dwordx4 v[248:251], v12, s[32:35], s77 offen offset:2048 nt
  buffer_load_dwordx4 v[252:255], v12, s[32:35], s77 offen offset:3072 nt
  s_nop 0
  s_waitcnt vmcnt(48)
  ds_write_b128 v13, v[32:35] offset:0
  ds_write_b128 v13, v[36:39] offset:1024
  ds_write_b128 v13, v[40:43] offset:2048
  ds_write_b128 v13, v[44:47] offset:3072
  ds_write_b128 v13, v[48:51] offset:4096
  ds_write_b128 v13, v[52:55] offset:5120
  ds_write_b128 v13, v[56:59] offset:6144
  ds_write_b128 v13, v[60:63] offset:7168
  s_waitcnt lgkmcnt(4)
  s_waitcnt vmcnt(40)
  ds_write_b128 v13, v[64:67] offset:8192
  ds_write_b128 v13, v[68:71] offset:9216
  ds_write_b128 v13, v[72:75] offset:10240
  ds_write_b128 v13, v[76:79] offset:11264
  ds_write_b128 v13, v[80:83] offset:12288
  ds_write_b128 v13, v[84:87] offset:13312
  ds_write_b128 v13, v[88:91] offset:14336
  ds_write_b128 v13, v[92:95] offset:15360
  s_waitcnt lgkmcnt(4)
  s_waitcnt vmcnt(32)
  ds_write_b128 v13, v[96:99] offset:16384
  ds_write_b128 v13, v[100:103] offset:17408
  ds_write_b128 v13, v[104:107] offset:18432
  ds_write_b128 v13, v[108:111] offset:19456
  ds_write_b128 v13, v[112:115] offset:20480
  ds_write_b128 v13, v[116:119] offset:21504
  ds_write_b128 v13, v[120:123] offset:22528
  ds_write_b128 v13, v[124:127] offset:23552
  s_waitcnt lgkmcnt(4)
  s_waitcnt vmcnt(24)
  ds_write_b128 v13, v[128:131] offset:24576
  ds_write_b128 v13, v[132:135] offset:25600
  ds_write_b128 v13, v[136:139] offset:26624
  ds_write_b128 v13, v[140:143] offset:27648
  ds_write_b128 v13, v[144:147] offset:28672
  ds_write_b128 v13, v[148:151] offset:29696
  ds_write_b128 v13, v[152:155] offset:30720
  ds_write_b128 v13, v[156:159] offset:31744
  s_waitcnt lgkmcnt(4)
  s_waitcnt vmcnt(16)
  ds_write_b128 v13, v[160:163] offset:32768
  ds_write_b128 v13, v[164:167] offset:33792
  ds_write_b128 v13, v[168:171] offset:34816
  ds_write_b128 v13, v[172:175] offset:35840
  ds_write_b128 v13, v[176:179] offset:36864
  ds_write_b128 v13, v[180:183] offset:37888
  ds_write_b128 v13, v[184:187] offset:38912
  ds_write_b128 v13, v[188:191] offset:39936
  s_waitcnt lgkmcnt(4)
  s_waitcnt vmcnt(8)
  ds_write_b128 v13, v[192:195] offset:40960
  ds_write_b128 v13, v[196:199] offset:41984
  ds_write_b128 v13, v[200:203] offset:43008
  ds_write_b128 v13, v[204:207] offset:44032
  ds_write_b128 v13, v[208:211] offset:45056
  ds_write_b128 v13, v[212:215] offset:46080
  ds_write_b128 v13, v[216:219] offset:47104
  ds_write_b128 v13, v[220:223] offset:48128
  s_waitcnt lgkmcnt(4)
  s_waitcnt vmcnt(0)
  ds_write_b128 v13, v[224:227] offset:49152
  ds_write_b128 v13, v[228:231] offset:50176
  ds_write_b128 v13, v[232:235] offset:51200
  ds_write_b128 v13, v[236:239] offset:52224
  ds_write_b128 v13, v[240:243] offset:53248
  ds_write_b128 v13, v[244:247] offset:54272
  ds_write_b128 v13, v[248:251] offset:55296
  ds_write_b128 v13, v[252:255] offset:56320
  s_waitcnt lgkmcnt(4)
  v_mov_b32 v12, 125716
  v_mov_b32 v13, 1
  s_mov_b64 exec, 1
  s_waitcnt lgkmcnt(0)
  ds_add_u32 v12, v13
  s_mov_b64 exec, -1
L_helper_end:
  v_mov_b32 v12, 125716
  s_mov_b32 s54, 0
L_lw_7:
  ds_read_b32 v13, v12
  s_add_u32 s54, s54, 1
  s_cmp_gt_u32 s54, 200000
  s_cbranch_scc1 L_lwx_8
  s_waitcnt lgkmcnt(0)
  v_cmp_le_u32 vcc, 2, v13
  s_cbranch_vccnz L_lwx_8
  s_sleep 8
  s_branch L_lw_7
L_lwx_8:
  s_waitcnt lgkmcnt(0)
  s_mul_i32 s48, s3, 224
  v_add_u32 v12, s48, v10
  v_add_u32 v13, 57344, v12
  ds_read_b64_tr_b16 v[128:129], v12 offset:0
  ds_read_b64_tr_b16 v[130:131], v12 offset:3584
  ds_read_b64_tr_b16 v[132:133], v12 offset:28672
  ds_read_b64_tr_b16 v[134:135], v12 offset:32256
  ds_read_b64_tr_b16 v[136:137], v13 offset:0
  ds_read_b64_tr_b16 v[138:139], v13 offset:3584
  ds_read_b64_tr_b16 v[140:141], v13 offset:28672
  ds_read_b64_tr_b16 v[142:143], v13 offset:32256
  s_waitcnt lgkmcnt(4)
  ds_read_b64_tr_b16 v[144:145], v12 offset:32
  ds_read_b64_tr_b16 v[146:147], v12 offset:3616
  ds_read_b64_tr_b16 v[148:149], v12 offset:28704
  ds_read_b64_tr_b16 v[150:151], v12 offset:32288
  ds_read_b64_tr_b16 v[152:153], v13 offset:32
  ds_read_b64_tr_b16 v[154:155], v13 offset:3616
  ds_read_b64_tr_b16 v[156:157], v13 offset:28704
  ds_read_b64_tr_b16 v[158:159], v13 offset:32288
  s_waitcnt lgkmcnt(4)
  ds_read_b64_tr_b16 v[160:161], v12 offset:64
  ds_read_b64_tr_b16 v[162:163], v12 offset:3648
  ds_read_b64_tr_b16 v[164:165], v12 offset:28736
  ds_read_b64_tr_b16 v[166:167], v12 offset:32320
  ds_read_b64_tr_b16 v[168:169], v13 offset:64
  ds_read_b64_tr_b16 v[170:171], v13 offset:3648
  ds_read_b64_tr_b16 v[172:173], v13 offset:28736
  ds_read_b64_tr_b16 v[174:175], v13 offset:32320
  s_waitcnt lgkmcnt(4)
  ds_read_b64_tr_b16 v[176:177], v12 offset:96
  ds_read_b64_tr_b16 v[178:179], v12 offset:3680
  ds_read_b64_tr_b16 v[180:181], v12 offset:28768
  ds_read_b64_tr_b16 v[182:183], v12 offset:32352
  ds_read_b64_tr_b16 v[184:185], v13 offset:96
  ds_read_b64_tr_b16 v[186:187], v13 offset:3680
  ds_read_b64_tr_b16 v[188:189], v13 offset:28768
  ds_read_b64_tr_b16 v[190:191], v13 offset:32352
  s_waitcnt lgkmcnt(4)
  ds_read_b64_tr_b16 v[192:193], v12 offset:128
  ds_read_b64_tr_b16 v[194:195], v12 offset:3712
  ds_read_b64_tr_b16 v[196:197], v12 offset:28800
  ds_read_b64_tr_b16 v[198:199], v12 offset:32384
  ds_read_b64_tr_b16 v[200:201], v13 offset:128
  ds_read_b64_tr_b16 v[202:203], v13 offset:3712
  ds_read_b64_tr_b16 v[204:205], v13 offset:28800
  ds_read_b64_tr_b16 v[206:207], v13 offset:32384
  s_waitcnt lgkmcnt(4)
  ds_read_b64_tr_b16 v[208:209], v12 offset:160
  ds_read_b64_tr_b16 v[210:211], v12 offset:3744
  ds_read_b64_tr_b16 v[212:213], v12 offset:28832
  ds_read_b64_tr_b16 v[214:215], v12 offset:32416
  ds_read_b64_tr_b16 v[216:217], v13 offset:160
  ds_read_b64_tr_b16 v[218:219], v13 offset:3744
  ds_read_b64_tr_b16 v[220:221], v13 offset:28832
  ds_read_b64_tr_b16 v[222:223], v13 offset:32416
  s_waitcnt lgkmcnt(4)
  ds_read_b64_tr_b16 v[224:225], v12 offset:192
  ds_read_b64_tr_b16 v[226:227], v12 offset:3776
  ds_read_b64_tr_b16 v[228:229], v12 offset:28864
  ds_read_b64_tr_b16 v[230:231], v12 offset:32448
  ds_read_b64_tr_b16 v[232:233], v13 offset:192
  ds_read_b64_tr_b16 v[234:235], v13 offset:3776
  ds_read_b64_tr_b16 v[236:237], v13 offset:28864
  ds_read_b64_tr_b16 v[238:239], v13 offset:32448
  s_waitcnt lgkmcnt(4)
  s_lshl_b32 s48, s3, 2
  s_add_u32 s48, s48, 125728
  v_mov_b32 v16, s48
  s_lshl_b32 s48, s3, 3
  s_add_u32 s48, s48, 125760
  v_mov_b32 v17, s48
  v_mov_b32 v18, 125712
  v_mov_b32 v19, 0
  s_lshl_b32 s52, s87, 7
  s_add_u32 s52, s52, 2686976
  s_mov_b32 s101, 0
  s_mov_b32 s100, 0
  s_mov_b64 exec, 1
  s_mov_b32 s54, 0
L_serve_gt:
  buffer_load_dwordx4 v[24:27], v19, s[36:39], s52 offen sc1
  s_add_u32 s54, s54, 1
  s_cmp_gt_u32 s54, 200000
  s_cbranch_scc1 L_serve
  s_waitcnt vmcnt(0)
  v_cmp_ne_u64 vcc, s[94:95], v[26:27]
  s_cbranch_vccnz L_serve_gt
L_serve:
  s_add_u32 s101, s101, 1
  s_mov_b32 s54, 0
L_serve_w:
  ds_read_b32 v20, v16
  s_add_u32 s54, s54, 1
  s_cmp_gt_u32 s54, 200000
  s_cbranch_scc1 L_serve_x
  s_waitcnt lgkmcnt(0)
  v_cmp_le_u32 vcc, s101, v20
  s_cbranch_vccnz L_serve_go
  s_sleep 2
  s_branch L_serve_w
L_serve_go:
  s_cmp_eq_u32 s100, 0
  s_cbranch_scc0 L_serve_g2
  v_mov_b32 v28, 1
  ds_add_rtn_u32 v28, v18, v28
  s_waitcnt lgkmcnt(0)
  v_readfirstlane_b32 s48, v28
  s_add_u32 s49, s48, s40
  s_cmp_lt_u32 s48, 52
  s_cbranch_scc1 L_serve_resp
  s_cmp_lt_u32 s3, 2
  s_cbranch_scc1 L_serve_g0
  s_cmp_lt_u32 s48, 56
  s_cselect_b32 s49, s49, 0xffff
  s_branch L_serve_resp
L_serve_g0:
  s_mov_b32 s100, 1
  v_mov_b32 v21, 1
  buffer_atomic_add v21, v19, s[36:39], s52 offen sc0 sc1
  s_cmp_lt_u32 s48, 56
  s_cbranch_scc1 L_serve_resp
L_serve_g2:
  s_waitcnt vmcnt(0)
  v_readfirstlane_b32 s48, v21
  s_and_b32 s49, s48, 3
  s_lshl_b32 s49, s49, 6
  s_lshr_b32 s50, s48, 2
  s_add_u32 s49, s49, s50
  s_add_u32 s49, s49, 56
  s_cmp_lt_u32 s48, 32
  s_cbranch_scc0 L_serve_end
  v_mov_b32 v21, 1
  buffer_atomic_add v21, v19, s[36:39], s52 offen sc0 sc1
  s_branch L_serve_resp
L_serve_end:
  v_mov_b32 v28, 1
  ds_add_rtn_u32 v28, v18, v28
  s_waitcnt lgkmcnt(0)
  v_readfirstlane_b32 s48, v28
  s_add_u32 s49, s48, s40
  s_cmp_lt_u32 s48, 56
  s_cselect_b32 s49, s49, 0xffff
L_serve_resp:
  v_mov_b32 v22, s101
  v_mov_b32 v23, s49
  ds_write_b64 v17, v[22:23]
  s_cmp_lt_u32 s49, 256
  s_cbranch_scc1 L_serve
L_serve_x:
  s_mov_b64 exec, -1
  s_waitcnt lgkmcnt(0)
  s_cmp_eq_u32 s3, 3
  s_cbranch_scc0 L_nofg
  s_cmp_lt_u32 s4, 7
  s_cbranch_scc0 L_nofg
  s_mul_i32 s53, s6, 896
  s_lshl_b32 s48, s90, 5
  s_add_u32 s53, s53, s48
  v_and_b32 v14, 7, v0
  v_lshlrev_b32 v14, 2, v14
  buffer_load_dword v19, v14, s[16:19], s53 offen
  s_mul_i32 s52, s6, 3584
  s_lshl_b32 s48, s90, 7
  s_add_u32 s52, s52, s48
  s_add_u32 s52, s52, 262144
  v_bfe_u32 v20, v0, 3, 2
  v_mul_u32_u24 v20, 28672, v20
  v_and_b32 v21, 7, v0
  v_lshl_add_u32 v20, v21, 4, v20
  s_mov_b32 s54, 0
  s_mov_b32 s58, 0xaaaaaaaa
  s_mov_b32 s59, 0xaaaaaaaa
L_fpoll:
  buffer_load_dwordx4 v[24:27], v20, s[36:39], s52 offen sc1
  s_add_u32 s54, s54, 1
  s_cmp_gt_u32 s54, 200000
  s_cbranch_scc1 L_fpoll_x
  s_waitcnt vmcnt(0)
  v_cndmask_b32 v40, v24, v26, s[58:59]
  v_cndmask_b32 v41, v25, v27, s[58:59]
  v_cmp_ne_u64 vcc, s[94:95], v[40:41]
  s_cbranch_vccz L_fpoll_x
  s_sleep 8
  s_branch L_fpoll
L_fpoll_x:
  s_waitcnt vmcnt(0)
  v_cndmask_b32 v40, v26, v24, s[58:59]
  v_cndmask_b32 v41, v27, v25, s[58:59]
  s_nop 1
  v_add_f32_dpp v40, v40, v40 row_ror:8 row_mask:0xf bank_mask:0xf
  v_add_f32_dpp v41, v41, v41 row_ror:8 row_mask:0xf bank_mask:0xf
  v_mov_b32 v42, v40
  v_mov_b32 v43, v41
  s_nop 0
  v_permlane16_swap_b32 v40, v42
  v_permlane16_swap_b32 v41, v43
  s_nop 0
  v_add_f32 v40, v40, v42
  v_add_f32 v41, v41, v43
  v_cvt_pk_bf16_f32 v42, v40, v41
  v_lshlrev_b32 v40, 16, v42
  v_and_b32 v41, 0xffff0000, v42
  v_mul_f32 v42, 0xbfb8aa3b, v40
  v_mul_f32 v43, 0xbfb8aa3b, v41
  v_exp_f32 v42, v42
  v_exp_f32 v43, v43
  s_nop 0
  v_add_f32 v42, 1.0, v42
  v_add_f32 v43, 1.0, v43
  v_rcp_f32 v42, v42
  v_rcp_f32 v43, v43
  s_nop 0
  v_mul_f32 v40, v40, v42
  v_mul_f32 v41, v41, v43
  v_cvt_pk_bf16_f32 v42, v40, v41
  v_lshlrev_b32 v16, 16, v42
  v_and_b32 v17, 0xffff0000, v42
  v_lshlrev_b32 v18, 16, v19
  v_and_b32 v19, 0xffff0000, v19
L_nofg:
  s_lshl_b32 s48, s6, 5
  s_add_u32 s48, s48, s90
  s_mul_i32 s53, s48, 3584
  s_mul_i32 s48, s3, 896
  s_add_u32 s53, s53, s48
  s_add_u32 s53, s53, 1703936
  v_and_b32 v11, 1, v0
  v_lshlrev_b32 v11, 4, v11
  v_lshl_add_u32 v11, v8, 5, v11
  v_lshlrev_b32 v9, 4, v8
  v_add_u32 v9, 125440, v9
  s_cmp_eq_u32 s3, 0
  s_cbranch_scc0 L_wait_o
  v_lshlrev_b32 v12, 10, v8
  v_lshl_add_u32 v12, v7, 4, v12
  s_lshl_b32 s48, s7, 8
  v_add_u32 v12, s48, v12
  v_lshlrev_b32 v13, 4, v8
  s_and_b32 s48, s91, 0xfc
  s_mul_i32 s52, s48, 2176
  s_add_u32 s52, s52, 1114112
  s_add_u32 s64, s52, 0
  s_add_u32 s65, s52, 2176
  s_add_u32 s66, s52, 4352
  s_add_u32 s67, s52, 6528
  s_mov_b32 exec_hi, 0
  buffer_load_dwordx4 v[48:51], v12, s[36:39], s64 offen sc1
  buffer_load_dwordx4 v[52:55], v12, s[36:39], s65 offen sc1
  buffer_load_dwordx4 v[56:59], v12, s[36:39], s66 offen sc1
  buffer_load_dwordx4 v[60:63], v12, s[36:39], s67 offen sc1
  buffer_load_dwordx4 v[64:67], v13, s[36:39], s64 offen offset:2048 sc1
  buffer_load_dwordx4 v[68:71], v13, s[36:39], s65 offen offset:2048 sc1
  buffer_load_dwordx4 v[72:75], v13, s[36:39], s66 offen offset:2048 sc1
  buffer_load_dwordx4 v[76:79], v13, s[36:39], s67 offen offset:2048 sc1
  s_mov_b32 exec_hi, -1
  v_mov_b32 v82, 125704
  s_mov_b32 s54, 0
L_lw_9:
  ds_read_b32 v83, v82
  s_add_u32 s54, s54, 1
  s_cmp_gt_u32 s54, 200000
  s_cbranch_scc1 L_lwx_10
  s_waitcnt lgkmcnt(0)
  v_cmp_le_u32 vcc, 4, v83
  s_cbranch_vccnz L_lwx_10
  s_sleep 1
  s_branch L_lw_9
L_lwx_10:
  s_waitcnt lgkmcnt(0)
  s_mov_b32 s54, 0
  s_mov_b32 exec_hi, 0
L_gpoll:
  buffer_load_dwordx4 v[48:51], v12, s[36:39], s64 offen sc1
  buffer_load_dwordx4 v[52:55], v12, s[36:39], s65 offen sc1
  buffer_load_dwordx4 v[56:59], v12, s[36:39], s66 offen sc1
  buffer_load_dwordx4 v[60:63], v12, s[36:39], s67 offen sc1
  buffer_load_dwordx4 v[64:67], v13, s[36:39], s64 offen offset:2048 sc1
  buffer_load_dwordx4 v[68:71], v13, s[36:39], s65 offen offset:2048 sc1
  buffer_load_dwordx4 v[72:75], v13, s[36:39], s66 offen offset:2048 sc1
  buffer_load_dwordx4 v[76:79], v13, s[36:39], s67 offen offset:2048 sc1
  s_add_u32 s54, s54, 1
  s_cmp_gt_u32 s54, 200000
  s_cbranch_scc1 L_gpoll_x
  s_waitcnt vmcnt(7)
  v_cmp_ne_u64 s[56:57], s[94:95], v[50:51]
  s_waitcnt vmcnt(6)
  v_cmp_ne_u64 vcc, s[94:95], v[54:55]
  s_or_b64 s[56:57], s[56:57], vcc
  s_waitcnt vmcnt(5)
  v_cmp_ne_u64 vcc, s[94:95], v[58:59]
  s_or_b64 s[56:57], s[56:57], vcc
  s_waitcnt vmcnt(4)
  v_cmp_ne_u64 vcc, s[94:95], v[62:63]
  s_or_b64 s[56:57], s[56:57], vcc
  s_waitcnt vmcnt(3)
  v_cmp_ne_u64 vcc, s[94:95], v[66:67]
  s_or_b64 s[56:57], s[56:57], vcc
  s_waitcnt vmcnt(2)
  v_cmp_ne_u64 vcc, s[94:95], v[70:71]
  s_or_b64 s[56:57], s[56:57], vcc
  s_waitcnt vmcnt(1)
  v_cmp_ne_u64 vcc, s[94:95], v[74:75]
  s_or_b64 s[56:57], s[56:57], vcc
  s_waitcnt vmcnt(0)
  v_cmp_ne_u64 vcc, s[94:95], v[78:79]
  s_or_b64 s[56:57], s[56:57], vcc
  s_cmp_lg_u64 s[56:57], 0
  s_cbranch_scc0 L_gpoll_x
  s_sleep 1
  s_branch L_gpoll
L_gpoll_x:
  s_waitcnt vmcnt(0)
  v_max3_f32 v80, v64, v68, v72
  v_max_f32 v80, v80, v76
  v_sub_f32 v64, v64, v80
  v_sub_f32 v68, v68, v80
  v_sub_f32 v72, v72, v80
  v_sub_f32 v76, v76, v80
  v_exp_f32 v64, v64
  v_exp_f32 v68, v68
  v_exp_f32 v72, v72
  v_exp_f32 v76, v76
  v_lshlrev_b32 v84, 16, v48
  v_and_b32 v85, 0xffff0000, v48
  v_lshlrev_b32 v86, 16, v49
  v_and_b32 v87, 0xffff0000, v49
  v_lshlrev_b32 v88, 16, v52
  v_and_b32 v89, 0xffff0000, v52
  v_lshlrev_b32 v90, 16, v53
  v_and_b32 v91, 0xffff0000, v53
  v_lshlrev_b32 v92, 16, v56
  v_and_b32 v93, 0xffff0000, v56
  v_lshlrev_b32 v94, 16, v57
  v_and_b32 v95, 0xffff0000, v57
  v_lshlrev_b32 v96, 16, v60
  v_and_b32 v97, 0xffff0000, v60
  v_lshlrev_b32 v98, 16, v61
  v_and_b32 v99, 0xffff0000, v61
  v_mul_f32 v81, v64, v65
  v_fmac_f32 v81, v68, v69
  v_fmac_f32 v81, v72, v73
  v_fmac_f32 v81, v76, v77
  v_rcp_f32 v81, v81
  v_mul_f32 v84, v64, v84
  v_mul_f32 v85, v64, v85
  v_mul_f32 v86, v64, v86
  v_mul_f32 v87, v64, v87
  v_fmac_f32 v84, v68, v88
  v_fmac_f32 v85, v68, v89
  v_fmac_f32 v86, v68, v90
  v_fmac_f32 v87, v68, v91
  v_fmac_f32 v84, v72, v92
  v_fmac_f32 v85, v72, v93
  v_fmac_f32 v86, v72, v94
  v_fmac_f32 v87, v72, v95
  v_fmac_f32 v84, v76, v96
  v_fmac_f32 v85, v76, v97
  v_fmac_f32 v86, v76, v98
  v_fmac_f32 v87, v76, v99
  v_mul_f32 v84, v84, v81
  v_mul_f32 v85, v85, v81
  v_mul_f32 v86, v86, v81
  v_mul_f32 v87, v87, v81
  v_cvt_pk_bf16_f32 v84, v84, v85
  v_cvt_pk_bf16_f32 v85, v86, v87
  v_lshlrev_b32 v12, 3, v0
  v_add_u32 v12, 125440, v12
  ds_write_b64 v12, v[84:85]
  s_mov_b64 exec, -1
  v_mov_b32 v12, 125708
  v_mov_b32 v13, 1
  s_waitcnt lgkmcnt(0)
  ds_write_b32 v12, v13
  s_branch L_gemv
L_wait_o:
  v_mov_b32 v12, 125704
  s_mov_b32 s54, 0
L_lw_11:
  ds_read_b32 v13, v12
  s_add_u32 s54, s54, 1
  s_cmp_gt_u32 s54, 200000
  s_cbranch_scc1 L_lwx_12
  s_waitcnt lgkmcnt(0)
  v_cmp_le_u32 vcc, 4, v13
  s_cbranch_vccnz L_lwx_12
  s_sleep 2
  s_branch L_lw_11
L_lwx_12:
  s_waitcnt lgkmcnt(0)
  v_mov_b32 v12, 125708
  s_mov_b32 s54, 0
L_lw_13:
  ds_read_b32 v13, v12
  s_add_u32 s54, s54, 1
  s_cmp_gt_u32 s54, 200000
  s_cbranch_scc1 L_lwx_14
  s_waitcnt lgkmcnt(0)
  v_cmp_le_u32 vcc, 1, v13
  s_cbranch_vccnz L_lwx_14
  s_sleep 1
  s_branch L_lw_13
L_lwx_14:
  s_waitcnt lgkmcnt(0)
L_gemv:
  ds_read_b128 v[48:51], v9 offset:0
  ds_read_b128 v[52:55], v9 offset:64
  ds_read_b128 v[56:59], v9 offset:128
  ds_read_b128 v[60:63], v9 offset:192
  s_mov_b32 s58, 0xaaaaaaaa
  s_mov_b32 s59, 0xaaaaaaaa
  v_mov_b32 v92, s94
  v_mov_b32 v93, s95
  s_mov_b32 s56, 0x00030003
  s_mov_b32 s57, 0x00030003
  s_waitcnt lgkmcnt(0)
  v_mfma_f32_16x16x32_bf16 v[64:67], v[128:131], v[48:51], 0
  v_mfma_f32_16x16x32_bf16 v[64:67], v[132:135], v[52:55], v[64:67]
  v_mfma_f32_16x16x32_bf16 v[64:67], v[136:139], v[56:59], v[64:67]
  v_mfma_f32_16x16x32_bf16 v[64:67], v[140:143], v[60:63], v[64:67]
  v_mfma_f32_16x16x32_bf16 v[68:71], v[144:147], v[48:51], 0
  v_mfma_f32_16x16x32_bf16 v[68:71], v[148:151], v[52:55], v[68:71]
  v_mfma_f32_16x16x32_bf16 v[68:71], v[152:155], v[56:59], v[68:71]
  v_mfma_f32_16x16x32_bf16 v[68:71], v[156:159], v[60:63], v[68:71]
  v_mfma_f32_16x16x32_bf16 v[72:75], v[160:163], v[48:51], 0
  v_mfma_f32_16x16x32_bf16 v[72:75], v[164:167], v[52:55], v[72:75]
  v_mfma_f32_16x16x32_bf16 v[72:75], v[168:171], v[56:59], v[72:75]
  v_mfma_f32_16x16x32_bf16 v[72:75], v[172:175], v[60:63], v[72:75]
  v_cndmask_b32 v96, v92, v66, s[58:59]
  v_cndmask_b32 v97, v93, v67, s[58:59]
  v_cndmask_b32 v98, v64, v92, s[58:59]
  v_cndmask_b32 v99, v65, v93, s[58:59]
  s_mov_b64 exec, s[56:57]
  buffer_store_dwordx4 v[96:99], v11, s[36:39], s53 offen offset:0 sc1
  s_mov_b64 exec, -1
  v_mfma_f32_16x16x32_bf16 v[76:79], v[176:179], v[48:51], 0
  v_mfma_f32_16x16x32_bf16 v[76:79], v[180:183], v[52:55], v[76:79]
  v_mfma_f32_16x16x32_bf16 v[76:79], v[184:187], v[56:59], v[76:79]
  v_mfma_f32_16x16x32_bf16 v[76:79], v[188:191], v[60:63], v[76:79]
  v_cndmask_b32 v100, v92, v70, s[58:59]
  v_cndmask_b32 v101, v93, v71, s[58:59]
  v_cndmask_b32 v102, v68, v92, s[58:59]
  v_cndmask_b32 v103, v69, v93, s[58:59]
  s_mov_b64 exec, s[56:57]
  buffer_store_dwordx4 v[100:103], v11, s[36:39], s53 offen offset:128 sc1
  s_mov_b64 exec, -1
  v_mfma_f32_16x16x32_bf16 v[80:83], v[192:195], v[48:51], 0
  v_mfma_f32_16x16x32_bf16 v[80:83], v[196:199], v[52:55], v[80:83]
  v_mfma_f32_16x16x32_bf16 v[80:83], v[200:203], v[56:59], v[80:83]
  v_mfma_f32_16x16x32_bf16 v[80:83], v[204:207], v[60:63], v[80:83]
  v_cndmask_b32 v104, v92, v74, s[58:59]
  v_cndmask_b32 v105, v93, v75, s[58:59]
  v_cndmask_b32 v106, v72, v92, s[58:59]
  v_cndmask_b32 v107, v73, v93, s[58:59]
  s_mov_b64 exec, s[56:57]
  buffer_store_dwordx4 v[104:107], v11, s[36:39], s53 offen offset:256 sc1
  s_mov_b64 exec, -1
  v_mfma_f32_16x16x32_bf16 v[84:87], v[208:211], v[48:51], 0
  v_mfma_f32_16x16x32_bf16 v[84:87], v[212:215], v[52:55], v[84:87]
  v_mfma_f32_16x16x32_bf16 v[84:87], v[216:219], v[56:59], v[84:87]
  v_mfma_f32_16x16x32_bf16 v[84:87], v[220:223], v[60:63], v[84:87]
  v_cndmask_b32 v108, v92, v78, s[58:59]
  v_cndmask_b32 v109, v93, v79, s[58:59]
  v_cndmask_b32 v110, v76, v92, s[58:59]
  v_cndmask_b32 v111, v77, v93, s[58:59]
  s_mov_b64 exec, s[56:57]
  buffer_store_dwordx4 v[108:111], v11, s[36:39], s53 offen offset:384 sc1
  s_mov_b64 exec, -1
  v_mfma_f32_16x16x32_bf16 v[88:91], v[224:227], v[48:51], 0
  v_mfma_f32_16x16x32_bf16 v[88:91], v[228:231], v[52:55], v[88:91]
  v_mfma_f32_16x16x32_bf16 v[88:91], v[232:235], v[56:59], v[88:91]
  v_mfma_f32_16x16x32_bf16 v[88:91], v[236:239], v[60:63], v[88:91]
  v_cndmask_b32 v112, v92, v82, s[58:59]
  v_cndmask_b32 v113, v93, v83, s[58:59]
  v_cndmask_b32 v114, v80, v92, s[58:59]
  v_cndmask_b32 v115, v81, v93, s[58:59]
  s_mov_b64 exec, s[56:57]
  buffer_store_dwordx4 v[112:115], v11, s[36:39], s53 offen offset:512 sc1
  s_mov_b64 exec, -1
  v_cndmask_b32 v116, v92, v86, s[58:59]
  v_cndmask_b32 v117, v93, v87, s[58:59]
  v_cndmask_b32 v118, v84, v92, s[58:59]
  v_cndmask_b32 v119, v85, v93, s[58:59]
  s_mov_b64 exec, s[56:57]
  buffer_store_dwordx4 v[116:119], v11, s[36:39], s53 offen offset:640 sc1
  s_mov_b64 exec, -1
  s_nop 0
  v_cndmask_b32 v120, v92, v90, s[58:59]
  v_cndmask_b32 v121, v93, v91, s[58:59]
  v_cndmask_b32 v122, v88, v92, s[58:59]
  v_cndmask_b32 v123, v89, v93, s[58:59]
  s_mov_b64 exec, s[56:57]
  buffer_store_dwordx4 v[120:123], v11, s[36:39], s53 offen offset:768 sc1
  s_mov_b64 exec, -1
  s_cmp_eq_u32 s3, 3
  s_cbranch_scc0 L_fin
  s_cmp_lt_u32 s4, 7
  s_cbranch_scc0 L_fin
  s_mul_i32 s52, s6, 114688
  s_lshl_b32 s48, s90, 7
  s_add_u32 s52, s52, s48
  s_add_u32 s52, s52, 1703936
  s_mul_i32 s53, s6, 896
  s_lshl_b32 s48, s90, 5
  s_add_u32 s53, s53, s48
  v_lshrrev_b32 v20, 3, v0
  v_mul_u32_u24 v20, 3584, v20
  v_and_b32 v21, 7, v0
  v_lshl_add_u32 v20, v21, 4, v20
  v_add_u32 v21, 28672, v20
  v_add_u32 v22, 57344, v20
  v_add_u32 v23, 86016, v20
  s_mov_b32 s54, 0
  s_mov_b32 s58, 0xaaaaaaaa
  s_mov_b32 s59, 0xaaaaaaaa
L_spoll:
  buffer_load_dwordx4 v[24:27], v20, s[36:39], s52 offen sc1
  buffer_load_dwordx4 v[28:31], v21, s[36:39], s52 offen sc1
  buffer_load_dwordx4 v[32:35], v22, s[36:39], s52 offen sc1
  buffer_load_dwordx4 v[36:39], v23, s[36:39], s52 offen sc1
  s_add_u32 s54, s54, 1
  s_cmp_gt_u32 s54, 200000
  s_cbranch_scc1 L_spoll_x
  s_waitcnt vmcnt(3)
  v_cndmask_b32 v40, v24, v26, s[58:59]
  v_cndmask_b32 v41, v25, v27, s[58:59]
  v_cmp_ne_u64 s[56:57], s[94:95], v[40:41]
  s_waitcnt vmcnt(2)
  v_cndmask_b32 v40, v28, v30, s[58:59]
  v_cndmask_b32 v41, v29, v31, s[58:59]
  v_cmp_ne_u64 vcc, s[94:95], v[40:41]
  s_or_b64 s[56:57], s[56:57], vcc
  s_waitcnt vmcnt(1)
  v_cndmask_b32 v40, v32, v34, s[58:59]
  v_cndmask_b32 v41, v33, v35, s[58:59]
  v_cmp_ne_u64 vcc, s[94:95], v[40:41]
  s_or_b64 s[56:57], s[56:57], vcc
  s_waitcnt vmcnt(0)
  v_cndmask_b32 v40, v36, v38, s[58:59]
  v_cndmask_b32 v41, v37, v39, s[58:59]
  v_cmp_ne_u64 vcc, s[94:95], v[40:41]
  s_or_b64 s[56:57], s[56:57], vcc
  s_and_b64 exec, exec, s[56:57]
  s_cbranch_execz L_spoll_x
  s_sleep 1
  s_branch L_spoll
L_spoll_x:
  s_mov_b64 exec, -1
  s_waitcnt vmcnt(0)
  v_cndmask_b32 v40, v26, v24, s[58:59]
  v_cndmask_b32 v41, v27, v25, s[58:59]
  v_cndmask_b32 v42, v30, v28, s[58:59]
  v_cndmask_b32 v43, v31, v29, s[58:59]
  v_cndmask_b32 v44, v34, v32, s[58:59]
  v_cndmask_b32 v45, v35, v33, s[58:59]
  v_cndmask_b32 v46, v38, v36, s[58:59]
  v_cndmask_b32 v47, v39, v37, s[58:59]
  v_add_f32 v40, v40, v42
  v_add_f32 v41, v41, v43
  v_add_f32 v44, v44, v46
  v_add_f32 v45, v45, v47
  v_add_f32 v40, v40, v44
  v_add_f32 v41, v41, v45
  s_nop 1
  v_add_f32_dpp v40, v40, v40 row_ror:8 row_mask:0xf bank_mask:0xf
  v_add_f32_dpp v41, v41, v41 row_ror:8 row_mask:0xf bank_mask:0xf
  v_mov_b32 v42, v40
  v_mov_b32 v43, v41
  s_nop 0
  v_permlane16_swap_b32 v40, v42
  v_permlane16_swap_b32 v41, v43
  s_nop 0
  v_add_f32 v40, v40, v42
  v_add_f32 v41, v41, v43
  v_mov_b32 v42, v40
  v_mov_b32 v43, v41
  s_nop 0
  v_permlane32_swap_b32 v40, v42
  v_permlane32_swap_b32 v41, v43
  s_nop 0
  v_add_f32 v40, v40, v42
  v_add_f32 v41, v41, v43
  v_cvt_pk_bf16_f32 v42, v40, v41
  v_lshlrev_b32 v40, 16, v42
  v_and_b32 v41, 0xffff0000, v42
  v_mul_f32 v40, v40, v16
  v_mul_f32 v41, v41, v17
  v_cvt_pk_bf16_f32 v42, v40, v41
  v_lshlrev_b32 v40, 16, v42
  v_and_b32 v41, 0xffff0000, v42
  v_add_f32 v40, v18, v40
  v_add_f32 v41, v19, v41
  v_cvt_pk_bf16_f32 v42, v40, v41
  s_mov_b64 exec, 0xff
  buffer_store_dword v42, v14, s[44:47], s53 offen
  s_mov_b64 exec, -1
  s_cmp_eq_u32 s2, 0
  s_cbranch_scc0 L_fin
  v_mov_b32 v24, s94
  v_mov_b32 v25, s95
  v_mov_b32 v22, 0
  s_mov_b64 exec, 1
  buffer_store_dwordx2 v[24:25], v22, s[36:39], 0 offen sc1
  s_mov_b64 exec, -1
  s_branch L_fin
L_stream:
  s_add_u32 s50, s51, 32768
  buffer_load_dwordx4 v[128:131], v1, s[8:11], s51 offen offset:0 nt
  buffer_load_dwordx4 v[132:135], v1, s[8:11], s51 offen offset:64 nt
  buffer_load_dwordx4 v[136:139], v1, s[8:11], s51 offen offset:128 nt
  buffer_load_dwordx4 v[140:143], v1, s[8:11], s51 offen offset:192 nt
  buffer_load_dwordx4 v[144:147], v1, s[8:11], s51 offen offset:256 nt
  buffer_load_dwordx4 v[148:151], v1, s[8:11], s51 offen offset:320 nt
  buffer_load_dwordx4 v[152:155], v1, s[8:11], s51 offen offset:384 nt
  buffer_load_dwordx4 v[156:159], v1, s[8:11], s51 offen offset:448 nt
  s_nop 0
  buffer_load_dwordx4 v[160:163], v2, s[12:15], s51 offen offset:0 nt
  buffer_load_dwordx4 v[164:167], v2, s[12:15], s51 offen offset:256 nt
  buffer_load_dwordx4 v[168:171], v2, s[12:15], s51 offen offset:512 nt
  buffer_load_dwordx4 v[172:175], v2, s[12:15], s51 offen offset:768 nt
  buffer_load_dwordx4 v[176:179], v2, s[12:15], s51 offen offset:1024 nt
  buffer_load_dwordx4 v[180:183], v2, s[12:15], s51 offen offset:1280 nt
  buffer_load_dwordx4 v[184:187], v2, s[12:15], s51 offen offset:1536 nt
  buffer_load_dwordx4 v[188:191], v2, s[12:15], s51 offen offset:1792 nt
  s_nop 0
  buffer_load_dwordx4 v[192:195], v1, s[8:11], s50 offen offset:0 nt
  buffer_load_dwordx4 v[196:199], v1, s[8:11], s50 offen offset:64 nt
  buffer_load_dwordx4 v[200:203], v1, s[8:11], s50 offen offset:128 nt
  buffer_load_dwordx4 v[204:207], v1, s[8:11], s50 offen offset:192 nt
  buffer_load_dwordx4 v[208:211], v1, s[8:11], s50 offen offset:256 nt
  buffer_load_dwordx4 v[212:215], v1, s[8:11], s50 offen offset:320 nt
  buffer_load_dwordx4 v[216:219], v1, s[8:11], s50 offen offset:384 nt
  buffer_load_dwordx4 v[220:223], v1, s[8:11], s50 offen offset:448 nt
  s_nop 0
  buffer_load_dwordx4 v[224:227], v2, s[12:15], s50 offen offset:0 nt
  buffer_load_dwordx4 v[228:231], v2, s[12:15], s50 offen offset:256 nt
  buffer_load_dwordx4 v[232:235], v2, s[12:15], s50 offen offset:512 nt
  buffer_load_dwordx4 v[236:239], v2, s[12:15], s50 offen offset:768 nt
  buffer_load_dwordx4 v[240:243], v2, s[12:15], s50 offen offset:1024 nt
  buffer_load_dwordx4 v[244:247], v2, s[12:15], s50 offen offset:1280 nt
  buffer_load_dwordx4 v[248:251], v2, s[12:15], s50 offen offset:1536 nt
  buffer_load_dwordx4 v[252:255], v2, s[12:15], s50 offen offset:1792 nt
  s_nop 0
  s_mov_b32 s93, 0x3db8aa3b
  s_mov_b32 s96, 0x00ff00ff
  s_mov_b32 s97, 0xff00ff00
  v_and_b32 v9, 1, v0
  v_lshlrev_b32 v9, 4, v9
  v_mov_b32 v10, 0xffff
  v_lshlrev_b32 v9, v9, v10
  v_bfe_u32 v10, v0, 1, 2
  v_cmp_eq_u32 vcc, 0, v10
  s_nop 1
  v_cndmask_b32 v3, 0, v9, vcc
  v_cmp_eq_u32 vcc, 1, v10
  s_nop 1
  v_cndmask_b32 v4, 0, v9, vcc
  v_cmp_eq_u32 vcc, 2, v10
  s_nop 1
  v_cndmask_b32 v5, 0, v9, vcc
  v_cmp_eq_u32 vcc, 3, v10
  s_nop 1
  v_cndmask_b32 v6, 0, v9, vcc
  s_waitcnt lgkmcnt(0)
  s_add_u32 s94, s94, 1
  s_mov_b32 s100, 0
  s_mov_b32 s101, 0
  s_and_b32 s49, s3, 3
  s_lshl_b32 s48, s49, 2
  s_add_u32 s48, s48, 125728
  v_mov_b32 v80, s48
  s_lshl_b32 s48, s49, 3
  s_add_u32 s48, s48, 125760
  v_mov_b32 v81, s48
  v_mov_b32 v12, 125696
  s_mov_b32 s54, 0
L_lw_15:
  ds_read_b32 v13, v12
  s_add_u32 s54, s54, 1
  s_cmp_gt_u32 s54, 200000
  s_cbranch_scc1 L_lwx_16
  s_waitcnt lgkmcnt(0)
  v_cmp_le_u32 vcc, 1, v13
  s_cbranch_vccnz L_lwx_16
  s_sleep 2
  s_branch L_lw_15
L_lwx_16:
  s_waitcnt lgkmcnt(0)
  v_lshrrev_b32 v13, 3, v7
  v_lshlrev_b32 v13, 9, v13
  v_lshl_add_u32 v13, v8, 4, v13
  v_add_u32 v13, 121984, v13
  ds_read_b128 v[16:19], v13 offset:0
  ds_read_b128 v[20:23], v13 offset:64
  ds_read_b128 v[24:27], v13 offset:128
  ds_read_b128 v[28:31], v13 offset:192
  ds_read_b128 v[32:35], v13 offset:256
  ds_read_b128 v[36:39], v13 offset:320
  ds_read_b128 v[40:43], v13 offset:384
  ds_read_b128 v[44:47], v13 offset:448
  v_mov_b32 v74, 125712
  v_mov_b32 v75, 1
  s_cmp_eq_u32 s100, 0
  s_cbranch_scc0 L_gm_17
  s_mov_b64 exec, 1
  ds_add_rtn_u32 v76, v74, v75
  s_mov_b64 exec, -1
  s_branch L_gd_18
L_gm_17:
  s_add_u32 s101, s101, 1
  v_mov_b32 v82, s101
  ds_write_b32 v80, v82
L_gd_18:
  v_mov_b32 v68, 0xf149f2ca
  v_mov_b32 v69, 0
  v_mov_b32 v52, 0
  v_mov_b32 v53, 0
  v_mov_b32 v54, 0
  v_mov_b32 v55, 0
  v_mov_b32 v56, 0
  v_mov_b32 v57, 0
  v_mov_b32 v58, 0
  v_mov_b32 v59, 0
  v_lshrrev_b32 v78, 1, v8
  v_lshlrev_b32 v78, 10, v78
  v_lshl_add_u32 v78, v7, 5, v78
  v_and_b32 v79, 1, v8
  v_lshl_add_u32 v78, v79, 4, v78
  s_and_b32 s49, s3, 3
  s_lshl_b32 s48, s49, 11
  s_add_u32 s48, s48, 125824
  v_add_u32 v78, s48, v78
  v_lshrrev_b32 v79, 3, v7
  v_lshlrev_b32 v79, 5, v79
  s_lshl_b32 s48, s49, 3
  s_add_u32 s48, s48, 125312
  v_add_u32 v79, s48, v79
  s_cmp_eq_u32 s100, 0
  s_cbranch_scc0 L_rm_19
  s_waitcnt lgkmcnt(0)
  v_readfirstlane_b32 s48, v76
  s_add_u32 s55, s48, s40
  s_cmp_lt_u32 s48, 44
  s_cbranch_scc1 L_rh_21
  s_mov_b32 s100, 1
  s_cmp_lt_u32 s48, 56
  s_cbranch_scc1 L_rh_21
  s_add_u32 s101, s101, 1
  v_mov_b32 v82, s101
  ds_write_b32 v80, v82
L_rm_19:
  s_mov_b32 s54, 0
  s_mov_b32 s55, 0xffff
L_rw_20:
  ds_read_b64 v[76:77], v81
  s_add_u32 s54, s54, 1
  s_cmp_gt_u32 s54, 200000
  s_cbranch_scc1 L_rx_22
  s_waitcnt lgkmcnt(0)
  v_readfirstlane_b32 s48, v76
  v_readfirstlane_b32 s55, v77
  s_cmp_eq_u32 s48, s101
  s_cbranch_scc1 L_rx_22
  s_mov_b32 s55, 0xffff
  s_sleep 1
  s_branch L_rw_20
L_rx_22:
  s_waitcnt lgkmcnt(0)
  s_cmp_lt_u32 s55, 256
  s_cbranch_scc0 L_noref_A
L_rh_21:
L_full_A:
  s_lshl_b32 s52, s55, 13
  s_cmp_eq_u32 s100, 0
  s_cbranch_scc0 L_gm_23
  s_mov_b64 exec, 1
  ds_add_rtn_u32 v76, v74, v75
  s_mov_b64 exec, -1
  s_branch L_gd_24
L_gm_23:
  s_add_u32 s101, s101, 1
  v_mov_b32 v82, s101
  ds_write_b32 v80, v82
L_gd_24:
  s_waitcnt vmcnt(24)
  v_mfma_f32_16x16x32_bf16 v[48:51], v[128:131], v[16:19], 0
  v_mfma_f32_16x16x32_bf16 v[48:51], v[132:135], v[20:23], v[48:51]
  v_mfma_f32_16x16x32_bf16 v[48:51], v[136:139], v[24:27], v[48:51]
  v_mfma_f32_16x16x32_bf16 v[48:51], v[140:143], v[28:31], v[48:51]
  v_mfma_f32_16x16x32_bf16 v[48:51], v[144:147], v[32:35], v[48:51]
  v_mfma_f32_16x16x32_bf16 v[48:51], v[148:151], v[36:39], v[48:51]
  v_mfma_f32_16x16x32_bf16 v[48:51], v[152:155], v[40:43], v[48:51]
  v_mfma_f32_16x16x32_bf16 v[48:51], v[156:159], v[44:47], v[48:51]
  s_nop 7
  v_max3_f32 v70, v48, v49, v50
  v_max_f32 v70, v70, v51
  v_mov_b32 v71, v70
  s_nop 1
  v_permlane16_swap_b32 v70, v71
  s_nop 1
  v_max_f32 v70, v70, v71
  v_mov_b32 v71, v70
  s_nop 1
  v_permlane32_swap_b32 v70, v71
  s_nop 1
  v_max_f32 v70, v70, v71
  v_mul_f32 v70, s93, v70
  v_max_f32 v70, v70, v68
  v_sub_f32 v72, v68, v70
  v_exp_f32 v72, v72
  v_mov_b32 v68, v70
  v_fma_f32 v48, v48, s93, -v70
  v_fma_f32 v49, v49, s93, -v70
  v_fma_f32 v50, v50, s93, -v70
  v_fma_f32 v51, v51, s93, -v70
  v_exp_f32 v48, v48
  v_exp_f32 v49, v49
  v_exp_f32 v50, v50
  v_exp_f32 v51, v51
  v_mov_b32_dpp v73, v72 row_ror:8 row_mask:0xf bank_mask:0xf
  v_mul_f32 v69, v69, v72
  v_cndmask_b32 v73, v73, v72, s[96:97]
  v_add_f32 v69, v69, v48
  v_cvt_pk_bf16_f32 v48, v48, v48
  v_add_f32 v69, v69, v49
  v_cvt_pk_bf16_f32 v49, v49, v49
  v_add_f32 v69, v69, v50
  v_cvt_pk_bf16_f32 v50, v50, v50
  v_add_f32 v69, v69, v51
  v_cvt_pk_bf16_f32 v51, v51, v51
  v_mul_f32 v52, v52, v73
  v_mul_f32 v53, v53, v73
  v_mul_f32 v54, v54, v73
  v_mul_f32 v55, v55, v73
  v_mul_f32 v56, v56, v73
  v_mul_f32 v57, v57, v73
  v_mul_f32 v58, v58, v73
  v_mul_f32 v59, v59, v73
  v_and_b32 v60, v48, v3
  v_and_b32 v61, v48, v4
  v_and_b32 v62, v48, v5
  v_and_b32 v63, v48, v6
  v_and_b32 v64, v49, v3
  v_and_b32 v65, v49, v4
  v_and_b32 v66, v49, v5
  v_and_b32 v67, v49, v6
  s_waitcnt vmcnt(16)
  v_mfma_f32_16x16x32_bf16 v[52:55], v[60:63], v[160:163], v[52:55]
  v_mfma_f32_16x16x32_bf16 v[56:59], v[60:63], v[164:167], v[56:59]
  v_and_b32 v60, v50, v3
  v_and_b32 v61, v50, v4
  v_and_b32 v62, v50, v5
  v_and_b32 v63, v50, v6
  v_mfma_f32_16x16x32_bf16 v[52:55], v[64:67], v[168:171], v[52:55]
  v_mfma_f32_16x16x32_bf16 v[56:59], v[64:67], v[172:175], v[56:59]
  v_and_b32 v64, v51, v3
  v_and_b32 v65, v51, v4
  v_and_b32 v66, v51, v5
  v_and_b32 v67, v51, v6
  v_mfma_f32_16x16x32_bf16 v[52:55], v[60:63], v[176:179], v[52:55]
  v_mfma_f32_16x16x32_bf16 v[56:59], v[60:63], v[180:183], v[56:59]
  v_mfma_f32_16x16x32_bf16 v[52:55], v[64:67], v[184:187], v[52:55]
  v_mfma_f32_16x16x32_bf16 v[56:59], v[64:67], v[188:191], v[56:59]
  buffer_load_dwordx4 v[128:131], v1, s[8:11], s52 offen offset:0 nt
  buffer_load_dwordx4 v[132:135], v1, s[8:11], s52 offen offset:64 nt
  buffer_load_dwordx4 v[136:139], v1, s[8:11], s52 offen offset:128 nt
  buffer_load_dwordx4 v[140:143], v1, s[8:11], s52 offen offset:192 nt
  buffer_load_dwordx4 v[144:147], v1, s[8:11], s52 offen offset:256 nt
  buffer_load_dwordx4 v[148:151], v1, s[8:11], s52 offen offset:320 nt
  buffer_load_dwordx4 v[152:155], v1, s[8:11], s52 offen offset:384 nt
  buffer_load_dwordx4 v[156:159], v1, s[8:11], s52 offen offset:448 nt
  buffer_load_dwordx4 v[160:163], v2, s[12:15], s52 offen offset:0 nt
  buffer_load_dwordx4 v[164:167], v2, s[12:15], s52 offen offset:256 nt
  buffer_load_dwordx4 v[168:171], v2, s[12:15], s52 offen offset:512 nt
  buffer_load_dwordx4 v[172:175], v2, s[12:15], s52 offen offset:768 nt
  buffer_load_dwordx4 v[176:179], v2, s[12:15], s52 offen offset:1024 nt
  buffer_load_dwordx4 v[180:183], v2, s[12:15], s52 offen offset:1280 nt
  buffer_load_dwordx4 v[184:187], v2, s[12:15], s52 offen offset:1536 nt
  buffer_load_dwordx4 v[188:191], v2, s[12:15], s52 offen offset:1792 nt
  s_cmp_eq_u32 s100, 0
  s_cbranch_scc0 L_rm_27
  s_waitcnt lgkmcnt(0)
  v_readfirstlane_b32 s48, v76
  s_add_u32 s55, s48, s40
  s_cmp_lt_u32 s48, 44
  s_cbranch_scc1 L_rh_29
  s_mov_b32 s100, 1
  s_cmp_lt_u32 s48, 56
  s_cbranch_scc1 L_rh_29
  s_add_u32 s101, s101, 1
  v_mov_b32 v82, s101
  ds_write_b32 v80, v82
L_rm_27:
  s_mov_b32 s54, 0
  s_mov_b32 s55, 0xffff
L_rw_28:
  ds_read_b64 v[76:77], v81
  s_add_u32 s54, s54, 1
  s_cmp_gt_u32 s54, 200000
  s_cbranch_scc1 L_rx_30
  s_waitcnt lgkmcnt(0)
  v_readfirstlane_b32 s48, v76
  v_readfirstlane_b32 s55, v77
  s_cmp_eq_u32 s48, s101
  s_cbranch_scc1 L_rx_30
  s_mov_b32 s55, 0xffff
  s_sleep 1
  s_branch L_rw_28
L_rx_30:
  s_waitcnt lgkmcnt(0)
  s_cmp_lt_u32 s55, 256
  s_cbranch_scc0 L_noref_B
L_rh_29:
L_full_B:
  s_lshl_b32 s52, s55, 13
  s_cmp_eq_u32 s100, 0
  s_cbranch_scc0 L_gm_31
  s_mov_b64 exec, 1
  ds_add_rtn_u32 v76, v74, v75
  s_mov_b64 exec, -1
  s_branch L_gd_32
L_gm_31:
  s_add_u32 s101, s101, 1
  v_mov_b32 v82, s101
  ds_write_b32 v80, v82
L_gd_32:
  s_waitcnt vmcnt(24)
  v_mfma_f32_16x16x32_bf16 v[48:51], v[192:195], v[16:19], 0
  v_mfma_f32_16x16x32_bf16 v[48:51], v[196:199], v[20:23], v[48:51]
  v_mfma_f32_16x16x32_bf16 v[48:51], v[200:203], v[24:27], v[48:51]
  v_mfma_f32_16x16x32_bf16 v[48:51], v[204:207], v[28:31], v[48:51]
  v_mfma_f32_16x16x32_bf16 v[48:51], v[208:211], v[32:35], v[48:51]
  v_mfma_f32_16x16x32_bf16 v[48:51], v[212:215], v[36:39], v[48:51]
  v_mfma_f32_16x16x32_bf16 v[48:51], v[216:219], v[40:43], v[48:51]
  v_mfma_f32_16x16x32_bf16 v[48:51], v[220:223], v[44:47], v[48:51]
  s_nop 7
  v_max3_f32 v70, v48, v49, v50
  v_max_f32 v70, v70, v51
  v_mov_b32 v71, v70
  s_nop 1
  v_permlane16_swap_b32 v70, v71
  s_nop 1
  v_max_f32 v70, v70, v71
  v_mov_b32 v71, v70
  s_nop 1
  v_permlane32_swap_b32 v70, v71
  s_nop 1
  v_max_f32 v70, v70, v71
  v_mul_f32 v70, s93, v70
  v_max_f32 v70, v70, v68
  v_sub_f32 v72, v68, v70
  v_exp_f32 v72, v72
  v_mov_b32 v68, v70
  v_fma_f32 v48, v48, s93, -v70
  v_fma_f32 v49, v49, s93, -v70
  v_fma_f32 v50, v50, s93, -v70
  v_fma_f32 v51, v51, s93, -v70
  v_exp_f32 v48, v48
  v_exp_f32 v49, v49
  v_exp_f32 v50, v50
  v_exp_f32 v51, v51
  v_mov_b32_dpp v73, v72 row_ror:8 row_mask:0xf bank_mask:0xf
  v_mul_f32 v69, v69, v72
  v_cndmask_b32 v73, v73, v72, s[96:97]
  v_add_f32 v69, v69, v48
  v_cvt_pk_bf16_f32 v48, v48, v48
  v_add_f32 v69, v69, v49
  v_cvt_pk_bf16_f32 v49, v49, v49
  v_add_f32 v69, v69, v50
  v_cvt_pk_bf16_f32 v50, v50, v50
  v_add_f32 v69, v69, v51
  v_cvt_pk_bf16_f32 v51, v51, v51
  v_mul_f32 v52, v52, v73
  v_mul_f32 v53, v53, v73
  v_mul_f32 v54, v54, v73
  v_mul_f32 v55, v55, v73
  v_mul_f32 v56, v56, v73
  v_mul_f32 v57, v57, v73
  v_mul_f32 v58, v58, v73
  v_mul_f32 v59, v59, v73
  v_and_b32 v60, v48, v3
  v_and_b32 v61, v48, v4
  v_and_b32 v62, v48, v5
  v_and_b32 v63, v48, v6
  v_and_b32 v64, v49, v3
  v_and_b32 v65, v49, v4
  v_and_b32 v66, v49, v5
  v_and_b32 v67, v49, v6
  s_waitcnt vmcnt(16)
  v_mfma_f32_16x16x32_bf16 v[52:55], v[60:63], v[224:227], v[52:55]
  v_mfma_f32_16x16x32_bf16 v[56:59], v[60:63], v[228:231], v[56:59]
  v_and_b32 v60, v50, v3
  v_and_b32 v61, v50, v4
  v_and_b32 v62, v50, v5
  v_and_b32 v63, v50, v6
  v_mfma_f32_16x16x32_bf16 v[52:55], v[64:67], v[232:235], v[52:55]
  v_mfma_f32_16x16x32_bf16 v[56:59], v[64:67], v[236:239], v[56:59]
  v_and_b32 v64, v51, v3
  v_and_b32 v65, v51, v4
  v_and_b32 v66, v51, v5
  v_and_b32 v67, v51, v6
  v_mfma_f32_16x16x32_bf16 v[52:55], v[60:63], v[240:243], v[52:55]
  v_mfma_f32_16x16x32_bf16 v[56:59], v[60:63], v[244:247], v[56:59]
  v_mfma_f32_16x16x32_bf16 v[52:55], v[64:67], v[248:251], v[52:55]
  v_mfma_f32_16x16x32_bf16 v[56:59], v[64:67], v[252:255], v[56:59]
  buffer_load_dwordx4 v[192:195], v1, s[8:11], s52 offen offset:0 nt
  buffer_load_dwordx4 v[196:199], v1, s[8:11], s52 offen offset:64 nt
  buffer_load_dwordx4 v[200:203], v1, s[8:11], s52 offen offset:128 nt
  buffer_load_dwordx4 v[204:207], v1, s[8:11], s52 offen offset:192 nt
  buffer_load_dwordx4 v[208:211], v1, s[8:11], s52 offen offset:256 nt
  buffer_load_dwordx4 v[212:215], v1, s[8:11], s52 offen offset:320 nt
  buffer_load_dwordx4 v[216:219], v1, s[8:11], s52 offen offset:384 nt
  buffer_load_dwordx4 v[220:223], v1, s[8:11], s52 offen offset:448 nt
  buffer_load_dwordx4 v[224:227], v2, s[12:15], s52 offen offset:0 nt
  buffer_load_dwordx4 v[228:231], v2, s[12:15], s52 offen offset:256 nt
  buffer_load_dwordx4 v[232:235], v2, s[12:15], s52 offen offset:512 nt
  buffer_load_dwordx4 v[236:239], v2, s[12:15], s52 offen offset:768 nt
  buffer_load_dwordx4 v[240:243], v2, s[12:15], s52 offen offset:1024 nt
  buffer_load_dwordx4 v[244:247], v2, s[12:15], s52 offen offset:1280 nt
  buffer_load_dwordx4 v[248:251], v2, s[12:15], s52 offen offset:1536 nt
  buffer_load_dwordx4 v[252:255], v2, s[12:15], s52 offen offset:1792 nt
  s_cmp_eq_u32 s100, 0
  s_cbranch_scc0 L_rm_35
  s_waitcnt lgkmcnt(0)
  v_readfirstlane_b32 s48, v76
  s_add_u32 s55, s48, s40
  s_cmp_lt_u32 s48, 44
  s_cbranch_scc1 L_rh_37
  s_mov_b32 s100, 1
  s_cmp_lt_u32 s48, 56
  s_cbranch_scc1 L_rh_37
  s_add_u32 s101, s101, 1
  v_mov_b32 v82, s101
  ds_write_b32 v80, v82
L_rm_35:
  s_mov_b32 s54, 0
  s_mov_b32 s55, 0xffff
L_rw_36:
  ds_read_b64 v[76:77], v81
  s_add_u32 s54, s54, 1
  s_cmp_gt_u32 s54, 200000
  s_cbranch_scc1 L_rx_38
  s_waitcnt lgkmcnt(0)
  v_readfirstlane_b32 s48, v76
  v_readfirstlane_b32 s55, v77
  s_cmp_eq_u32 s48, s101
  s_cbranch_scc1 L_rx_38
  s_mov_b32 s55, 0xffff
  s_sleep 1
  s_branch L_rw_36
L_rx_38:
  s_waitcnt lgkmcnt(0)
  s_cmp_lt_u32 s55, 256
  s_cbranch_scc0 L_noref_A
L_rh_37:
  s_branch L_full_A
L_noref_A:
  v_mov_b32 v70, 125720
  s_mov_b32 s54, 0
L_lw_39:
  ds_read_b32 v71, v70
  s_add_u32 s54, s54, 1
  s_cmp_gt_u32 s54, 200000
  s_cbranch_scc1 L_lwx_40
  s_waitcnt lgkmcnt(0)
  v_cmp_le_u32 vcc, 1, v71
  s_cbranch_vccnz L_lwx_40
  s_sleep 2
  s_branch L_lw_39
L_lwx_40:
  s_waitcnt lgkmcnt(0)
  s_waitcnt vmcnt(24)
  v_mfma_f32_16x16x32_bf16 v[48:51], v[128:131], v[16:19], 0
  v_mfma_f32_16x16x32_bf16 v[48:51], v[132:135], v[20:23], v[48:51]
  v_mfma_f32_16x16x32_bf16 v[48:51], v[136:139], v[24:27], v[48:51]
  v_mfma_f32_16x16x32_bf16 v[48:51], v[140:143], v[28:31], v[48:51]
  v_mfma_f32_16x16x32_bf16 v[48:51], v[144:147], v[32:35], v[48:51]
  v_mfma_f32_16x16x32_bf16 v[48:51], v[148:151], v[36:39], v[48:51]
  v_mfma_f32_16x16x32_bf16 v[48:51], v[152:155], v[40:43], v[48:51]
  v_mfma_f32_16x16x32_bf16 v[48:51], v[156:159], v[44:47], v[48:51]
  s_nop 7
  v_max3_f32 v70, v48, v49, v50
  v_max_f32 v70, v70, v51
  v_mov_b32 v71, v70
  s_nop 1
  v_permlane16_swap_b32 v70, v71
  s_nop 1
  v_max_f32 v70, v70, v71
  v_mov_b32 v71, v70
  s_nop 1
  v_permlane32_swap_b32 v70, v71
  s_nop 1
  v_max_f32 v70, v70, v71
  v_mul_f32 v70, s93, v70
  v_max_f32 v70, v70, v68
  v_sub_f32 v72, v68, v70
  v_exp_f32 v72, v72
  v_mov_b32 v68, v70
  v_fma_f32 v48, v48, s93, -v70
  v_fma_f32 v49, v49, s93, -v70
  v_fma_f32 v50, v50, s93, -v70
  v_fma_f32 v51, v51, s93, -v70
  v_exp_f32 v48, v48
  v_exp_f32 v49, v49
  v_exp_f32 v50, v50
  v_exp_f32 v51, v51
  v_mov_b32_dpp v73, v72 row_ror:8 row_mask:0xf bank_mask:0xf
  v_mul_f32 v69, v69, v72
  v_cndmask_b32 v73, v73, v72, s[96:97]
  v_add_f32 v69, v69, v48
  v_cvt_pk_bf16_f32 v48, v48, v48
  v_add_f32 v69, v69, v49
  v_cvt_pk_bf16_f32 v49, v49, v49
  v_add_f32 v69, v69, v50
  v_cvt_pk_bf16_f32 v50, v50, v50
  v_add_f32 v69, v69, v51
  v_cvt_pk_bf16_f32 v51, v51, v51
  v_mul_f32 v52, v52, v73
  v_mul_f32 v53, v53, v73
  v_mul_f32 v54, v54, v73
  v_mul_f32 v55, v55, v73
  v_mul_f32 v56, v56, v73
  v_mul_f32 v57, v57, v73
  v_mul_f32 v58, v58, v73
  v_mul_f32 v59, v59, v73
  v_and_b32 v60, v48, v3
  v_and_b32 v61, v48, v4
  v_and_b32 v62, v48, v5
  v_and_b32 v63, v48, v6
  v_and_b32 v64, v49, v3
  v_and_b32 v65, v49, v4
  v_and_b32 v66, v49, v5
  v_and_b32 v67, v49, v6
  s_waitcnt vmcnt(16)
  v_mfma_f32_16x16x32_bf16 v[52:55], v[60:63], v[160:163], v[52:55]
  v_mfma_f32_16x16x32_bf16 v[56:59], v[60:63], v[164:167], v[56:59]
  v_and_b32 v60, v50, v3
  v_and_b32 v61, v50, v4
  v_and_b32 v62, v50, v5
  v_and_b32 v63, v50, v6
  v_mfma_f32_16x16x32_bf16 v[52:55], v[64:67], v[168:171], v[52:55]
  v_mfma_f32_16x16x32_bf16 v[56:59], v[64:67], v[172:175], v[56:59]
  v_and_b32 v64, v51, v3
  v_and_b32 v65, v51, v4
  v_and_b32 v66, v51, v5
  v_and_b32 v67, v51, v6
  v_mfma_f32_16x16x32_bf16 v[52:55], v[60:63], v[176:179], v[52:55]
  v_mfma_f32_16x16x32_bf16 v[56:59], v[60:63], v[180:183], v[56:59]
  v_mfma_f32_16x16x32_bf16 v[52:55], v[64:67], v[184:187], v[52:55]
  v_mfma_f32_16x16x32_bf16 v[56:59], v[64:67], v[188:191], v[56:59]
L_last_B:
  s_waitcnt vmcnt(8)
  v_mfma_f32_16x16x32_bf16 v[48:51], v[192:195], v[16:19], 0
  v_mfma_f32_16x16x32_bf16 v[48:51], v[196:199], v[20:23], v[48:51]
  v_mfma_f32_16x16x32_bf16 v[48:51], v[200:203], v[24:27], v[48:51]
  v_mfma_f32_16x16x32_bf16 v[48:51], v[204:207], v[28:31], v[48:51]
  v_mfma_f32_16x16x32_bf16 v[48:51], v[208:211], v[32:35], v[48:51]
  v_mfma_f32_16x16x32_bf16 v[48:51], v[212:215], v[36:39], v[48:51]
  v_mfma_f32_16x16x32_bf16 v[48:51], v[216:219], v[40:43], v[48:51]
  v_mfma_f32_16x16x32_bf16 v[48:51], v[220:223], v[44:47], v[48:51]
  s_nop 7
  v_max3_f32 v70, v48, v49, v50
  v_max_f32 v70, v70, v51
  v_mov_b32 v71, v70
  s_nop 1
  v_permlane16_swap_b32 v70, v71
  s_nop 1
  v_max_f32 v70, v70, v71
  v_mov_b32 v71, v70
  s_nop 1
  v_permlane32_swap_b32 v70, v71
  s_nop 1
  v_max_f32 v70, v70, v71
  v_mul_f32 v70, s93, v70
  v_max_f32 v70, v70, v68
  v_sub_f32 v72, v68, v70
  v_exp_f32 v72, v72
  v_mov_b32 v68, v70
  v_fma_f32 v48, v48, s93, -v70
  v_fma_f32 v49, v49, s93, -v70
  v_fma_f32 v50, v50, s93, -v70
  v_fma_f32 v51, v51, s93, -v70
  v_exp_f32 v48, v48
  v_exp_f32 v49, v49
  v_exp_f32 v50, v50
  v_exp_f32 v51, v51
  v_mov_b32_dpp v73, v72 row_ror:8 row_mask:0xf bank_mask:0xf
  v_mul_f32 v69, v69, v72
  v_cndmask_b32 v73, v73, v72, s[96:97]
  v_add_f32 v69, v69, v48
  v_cvt_pk_bf16_f32 v48, v48, v48
  v_add_f32 v69, v69, v49
  v_cvt_pk_bf16_f32 v49, v49, v49
  v_add_f32 v69, v69, v50
  v_cvt_pk_bf16_f32 v50, v50, v50
  v_add_f32 v69, v69, v51
  v_cvt_pk_bf16_f32 v51, v51, v51
  v_mul_f32 v52, v52, v73
  v_mul_f32 v53, v53, v73
  v_mul_f32 v54, v54, v73
  v_mul_f32 v55, v55, v73
  v_mul_f32 v56, v56, v73
  v_mul_f32 v57, v57, v73
  v_mul_f32 v58, v58, v73
  v_mul_f32 v59, v59, v73
  v_and_b32 v60, v48, v3
  v_and_b32 v61, v48, v4
  v_and_b32 v62, v48, v5
  v_and_b32 v63, v48, v6
  v_and_b32 v64, v49, v3
  v_and_b32 v65, v49, v4
  v_and_b32 v66, v49, v5
  v_and_b32 v67, v49, v6
  v_mov_b32 v71, v69
  s_nop 1
  v_permlane16_swap_b32 v69, v71
  s_nop 1
  v_add_f32 v69, v69, v71
  v_mov_b32 v71, v69
  s_nop 1
  v_permlane32_swap_b32 v69, v71
  s_nop 1
  v_add_f32 v69, v69, v71
  ds_write_b64 v79, v[68:69]
  s_waitcnt vmcnt(0)
  v_mfma_f32_16x16x32_bf16 v[52:55], v[60:63], v[224:227], v[52:55]
  v_mfma_f32_16x16x32_bf16 v[56:59], v[60:63], v[228:231], v[56:59]
  v_and_b32 v60, v50, v3
  v_and_b32 v61, v50, v4
  v_and_b32 v62, v50, v5
  v_and_b32 v63, v50, v6
  v_mfma_f32_16x16x32_bf16 v[52:55], v[64:67], v[232:235], v[52:55]
  v_mfma_f32_16x16x32_bf16 v[56:59], v[64:67], v[236:239], v[56:59]
  v_and_b32 v64, v51, v3
  v_and_b32 v65, v51, v4
  v_and_b32 v66, v51, v5
  v_and_b32 v67, v51, v6
  v_mfma_f32_16x16x32_bf16 v[52:55], v[60:63], v[240:243], v[52:55]
  v_mfma_f32_16x16x32_bf16 v[56:59], v[60:63], v[244:247], v[56:59]
  v_mfma_f32_16x16x32_bf16 v[52:55], v[64:67], v[248:251], v[52:55]
  v_mfma_f32_16x16x32_bf16 v[56:59], v[64:67], v[252:255], v[56:59]
  s_branch L_done
L_noref_B:
  v_mov_b32 v70, 125720
  s_mov_b32 s54, 0
L_lw_45:
  ds_read_b32 v71, v70
  s_add_u32 s54, s54, 1
  s_cmp_gt_u32 s54, 200000
  s_cbranch_scc1 L_lwx_46
  s_waitcnt lgkmcnt(0)
  v_cmp_le_u32 vcc, 1, v71
  s_cbranch_vccnz L_lwx_46
  s_sleep 2
  s_branch L_lw_45
L_lwx_46:
  s_waitcnt lgkmcnt(0)
  s_waitcnt vmcnt(24)
  v_mfma_f32_16x16x32_bf16 v[48:51], v[192:195], v[16:19], 0
  v_mfma_f32_16x16x32_bf16 v[48:51], v[196:199], v[20:23], v[48:51]
  v_mfma_f32_16x16x32_bf16 v[48:51], v[200:203], v[24:27], v[48:51]
  v_mfma_f32_16x16x32_bf16 v[48:51], v[204:207], v[28:31], v[48:51]
  v_mfma_f32_16x16x32_bf16 v[48:51], v[208:211], v[32:35], v[48:51]
  v_mfma_f32_16x16x32_bf16 v[48:51], v[212:215], v[36:39], v[48:51]
  v_mfma_f32_16x16x32_bf16 v[48:51], v[216:219], v[40:43], v[48:51]
  v_mfma_f32_16x16x32_bf16 v[48:51], v[220:223], v[44:47], v[48:51]
  s_nop 7
  v_max3_f32 v70, v48, v49, v50
  v_max_f32 v70, v70, v51
  v_mov_b32 v71, v70
  s_nop 1
  v_permlane16_swap_b32 v70, v71
  s_nop 1
  v_max_f32 v70, v70, v71
  v_mov_b32 v71, v70
  s_nop 1
  v_permlane32_swap_b32 v70, v71
  s_nop 1
  v_max_f32 v70, v70, v71
  v_mul_f32 v70, s93, v70
  v_max_f32 v70, v70, v68
  v_sub_f32 v72, v68, v70
  v_exp_f32 v72, v72
  v_mov_b32 v68, v70
  v_fma_f32 v48, v48, s93, -v70
  v_fma_f32 v49, v49, s93, -v70
  v_fma_f32 v50, v50, s93, -v70
  v_fma_f32 v51, v51, s93, -v70
  v_exp_f32 v48, v48
  v_exp_f32 v49, v49
  v_exp_f32 v50, v50
  v_exp_f32 v51, v51
  v_mov_b32_dpp v73, v72 row_ror:8 row_mask:0xf bank_mask:0xf
  v_mul_f32 v69, v69, v72
  v_cndmask_b32 v73, v73, v72, s[96:97]
  v_add_f32 v69, v69, v48
  v_cvt_pk_bf16_f32 v48, v48, v48
  v_add_f32 v69, v69, v49
  v_cvt_pk_bf16_f32 v49, v49, v49
  v_add_f32 v69, v69, v50
  v_cvt_pk_bf16_f32 v50, v50, v50
  v_add_f32 v69, v69, v51
  v_cvt_pk_bf16_f32 v51, v51, v51
  v_mul_f32 v52, v52, v73
  v_mul_f32 v53, v53, v73
  v_mul_f32 v54, v54, v73
  v_mul_f32 v55, v55, v73
  v_mul_f32 v56, v56, v73
  v_mul_f32 v57, v57, v73
  v_mul_f32 v58, v58, v73
  v_mul_f32 v59, v59, v73
  v_and_b32 v60, v48, v3
  v_and_b32 v61, v48, v4
  v_and_b32 v62, v48, v5
  v_and_b32 v63, v48, v6
  v_and_b32 v64, v49, v3
  v_and_b32 v65, v49, v4
  v_and_b32 v66, v49, v5
  v_and_b32 v67, v49, v6
  s_waitcnt vmcnt(16)
  v_mfma_f32_16x16x32_bf16 v[52:55], v[60:63], v[224:227], v[52:55]
  v_mfma_f32_16x16x32_bf16 v[56:59], v[60:63], v[228:231], v[56:59]
  v_and_b32 v60, v50, v3
  v_and_b32 v61, v50, v4
  v_and_b32 v62, v50, v5
  v_and_b32 v63, v50, v6
  v_mfma_f32_16x16x32_bf16 v[52:55], v[64:67], v[232:235], v[52:55]
  v_mfma_f32_16x16x32_bf16 v[56:59], v[64:67], v[236:239], v[56:59]
  v_and_b32 v64, v51, v3
  v_and_b32 v65, v51, v4
  v_and_b32 v66, v51, v5
  v_and_b32 v67, v51, v6
  v_mfma_f32_16x16x32_bf16 v[52:55], v[60:63], v[240:243], v[52:55]
  v_mfma_f32_16x16x32_bf16 v[56:59], v[60:63], v[244:247], v[56:59]
  v_mfma_f32_16x16x32_bf16 v[52:55], v[64:67], v[248:251], v[52:55]
  v_mfma_f32_16x16x32_bf16 v[56:59], v[64:67], v[252:255], v[56:59]
L_last_A:
  s_waitcnt vmcnt(8)
  v_mfma_f32_16x16x32_bf16 v[48:51], v[128:131], v[16:19], 0
  v_mfma_f32_16x16x32_bf16 v[48:51], v[132:135], v[20:23], v[48:51]
  v_mfma_f32_16x16x32_bf16 v[48:51], v[136:139], v[24:27], v[48:51]
  v_mfma_f32_16x16x32_bf16 v[48:51], v[140:143], v[28:31], v[48:51]
  v_mfma_f32_16x16x32_bf16 v[48:51], v[144:147], v[32:35], v[48:51]
  v_mfma_f32_16x16x32_bf16 v[48:51], v[148:151], v[36:39], v[48:51]
  v_mfma_f32_16x16x32_bf16 v[48:51], v[152:155], v[40:43], v[48:51]
  v_mfma_f32_16x16x32_bf16 v[48:51], v[156:159], v[44:47], v[48:51]
  s_nop 7
  v_max3_f32 v70, v48, v49, v50
  v_max_f32 v70, v70, v51
  v_mov_b32 v71, v70
  s_nop 1
  v_permlane16_swap_b32 v70, v71
  s_nop 1
  v_max_f32 v70, v70, v71
  v_mov_b32 v71, v70
  s_nop 1
  v_permlane32_swap_b32 v70, v71
  s_nop 1
  v_max_f32 v70, v70, v71
  v_mul_f32 v70, s93, v70
  v_max_f32 v70, v70, v68
  v_sub_f32 v72, v68, v70
  v_exp_f32 v72, v72
  v_mov_b32 v68, v70
  v_fma_f32 v48, v48, s93, -v70
  v_fma_f32 v49, v49, s93, -v70
  v_fma_f32 v50, v50, s93, -v70
  v_fma_f32 v51, v51, s93, -v70
  v_exp_f32 v48, v48
  v_exp_f32 v49, v49
  v_exp_f32 v50, v50
  v_exp_f32 v51, v51
  v_mov_b32_dpp v73, v72 row_ror:8 row_mask:0xf bank_mask:0xf
  v_mul_f32 v69, v69, v72
  v_cndmask_b32 v73, v73, v72, s[96:97]
  v_add_f32 v69, v69, v48
  v_cvt_pk_bf16_f32 v48, v48, v48
  v_add_f32 v69, v69, v49
  v_cvt_pk_bf16_f32 v49, v49, v49
  v_add_f32 v69, v69, v50
  v_cvt_pk_bf16_f32 v50, v50, v50
  v_add_f32 v69, v69, v51
  v_cvt_pk_bf16_f32 v51, v51, v51
  v_mul_f32 v52, v52, v73
  v_mul_f32 v53, v53, v73
  v_mul_f32 v54, v54, v73
  v_mul_f32 v55, v55, v73
  v_mul_f32 v56, v56, v73
  v_mul_f32 v57, v57, v73
  v_mul_f32 v58, v58, v73
  v_mul_f32 v59, v59, v73
  v_and_b32 v60, v48, v3
  v_and_b32 v61, v48, v4
  v_and_b32 v62, v48, v5
  v_and_b32 v63, v48, v6
  v_and_b32 v64, v49, v3
  v_and_b32 v65, v49, v4
  v_and_b32 v66, v49, v5
  v_and_b32 v67, v49, v6
  v_mov_b32 v71, v69
  s_nop 1
  v_permlane16_swap_b32 v69, v71
  s_nop 1
  v_add_f32 v69, v69, v71
  v_mov_b32 v71, v69
  s_nop 1
  v_permlane32_swap_b32 v69, v71
  s_nop 1
  v_add_f32 v69, v69, v71
  ds_write_b64 v79, v[68:69]
  s_waitcnt vmcnt(0)
  v_mfma_f32_16x16x32_bf16 v[52:55], v[60:63], v[160:163], v[52:55]
  v_mfma_f32_16x16x32_bf16 v[56:59], v[60:63], v[164:167], v[56:59]
  v_and_b32 v60, v50, v3
  v_and_b32 v61, v50, v4
  v_and_b32 v62, v50, v5
  v_and_b32 v63, v50, v6
  v_mfma_f32_16x16x32_bf16 v[52:55], v[64:67], v[168:171], v[52:55]
  v_mfma_f32_16x16x32_bf16 v[56:59], v[64:67], v[172:175], v[56:59]
  v_and_b32 v64, v51, v3
  v_and_b32 v65, v51, v4
  v_and_b32 v66, v51, v5
  v_and_b32 v67, v51, v6
  v_mfma_f32_16x16x32_bf16 v[52:55], v[60:63], v[176:179], v[52:55]
  v_mfma_f32_16x16x32_bf16 v[56:59], v[60:63], v[180:183], v[56:59]
  v_mfma_f32_16x16x32_bf16 v[52:55], v[64:67], v[184:187], v[52:55]
  v_mfma_f32_16x16x32_bf16 v[56:59], v[64:67], v[188:191], v[56:59]
L_done:
  s_setprio 3
  v_mov_b32 v20, 125704
  v_mov_b32 v21, 1
  v_lshlrev_b32 v18, 4, v0
  v_add_u32 v19, 125824, v18
  v_mov_b32 v17, 125312
  s_nop 2
  ds_write_b128 v78, v[52:55]
  ds_write_b128 v78, v[56:59] offset:512
  s_mov_b64 exec, 1
  s_waitcnt lgkmcnt(0)
  ds_add_rtn_u32 v21, v20, v21
  s_mov_b64 exec, -1
  s_mul_i32 s52, s91, 2176
  s_add_u32 s52, s52, 1114112
  v_mov_b32 v46, s94
  v_mov_b32 v47, s95
  v_mov_b32 v50, s94
  v_mov_b32 v51, s95
  v_mov_b32 v54, s94
  v_mov_b32 v55, s95
  s_waitcnt lgkmcnt(0)
  v_readfirstlane_b32 s92, v21
  s_cmp_eq_u32 s92, 3
  s_cbranch_scc0 L_fin
  ds_read_b128 v[20:23], v17 offset:0
  ds_read_b128 v[24:27], v17 offset:16
  ds_read_b128 v[28:31], v17 offset:32
  ds_read_b128 v[32:35], v17 offset:48
  ds_read_b128 v[96:99], v19 offset:0
  ds_read_b128 v[100:103], v19 offset:1024
  ds_read_b128 v[104:107], v19 offset:2048
  ds_read_b128 v[108:111], v19 offset:3072
  ds_read_b128 v[112:115], v19 offset:4096
  ds_read_b128 v[116:119], v19 offset:5120
  ds_read_b128 v[120:123], v19 offset:6144
  ds_read_b128 v[124:127], v19 offset:7168
  s_waitcnt lgkmcnt(8)
  v_max3_f32 v60, v20, v22, v24
  v_max3_f32 v62, v28, v30, v32
  v_max_f32 v60, v60, v26
  v_max_f32 v62, v62, v34
  v_sub_f32 v20, v20, v60
  v_sub_f32 v28, v28, v62
  v_sub_f32 v22, v22, v60
  v_sub_f32 v30, v30, v62
  v_sub_f32 v24, v24, v60
  v_sub_f32 v32, v32, v62
  v_sub_f32 v26, v26, v60
  v_sub_f32 v34, v34, v62
  v_exp_f32 v20, v20
  v_exp_f32 v22, v22
  v_exp_f32 v24, v24
  v_exp_f32 v26, v26
  v_exp_f32 v28, v28
  v_exp_f32 v30, v30
  v_exp_f32 v32, v32
  v_exp_f32 v34, v34
  v_cmp_eq_u32 vcc, 1, v0
  v_mul_f32 v61, v20, v21
  v_mul_f32 v63, v28, v29
  v_fmac_f32 v61, v22, v23
  v_fmac_f32 v63, v30, v31
  v_fmac_f32 v61, v24, v25
  v_fmac_f32 v63, v32, v33
  v_fmac_f32 v61, v26, v27
  v_fmac_f32 v63, v34, v35
  v_cndmask_b32 v52, v60, v62, vcc
  v_cndmask_b32 v53, v61, v63, vcc
  s_mov_b64 exec, 3
  buffer_store_dwordx4 v[52:55], v18, s[36:39], s52 offen offset:2048 sc1
  s_mov_b64 exec, -1
  s_waitcnt lgkmcnt(6)
  v_mul_f32 v36, v20, v96
  v_mul_f32 v37, v20, v97
  v_mul_f32 v38, v20, v98
  v_mul_f32 v39, v20, v99
  v_mul_f32 v40, v28, v100
  v_mul_f32 v41, v28, v101
  v_mul_f32 v42, v28, v102
  v_mul_f32 v43, v28, v103
  s_waitcnt lgkmcnt(4)
  v_fmac_f32 v36, v22, v104
  v_fmac_f32 v37, v22, v105
  v_fmac_f32 v38, v22, v106
  v_fmac_f32 v39, v22, v107
  v_fmac_f32 v40, v30, v108
  v_fmac_f32 v41, v30, v109
  v_fmac_f32 v42, v30, v110
  v_fmac_f32 v43, v30, v111
  s_waitcnt lgkmcnt(2)
  v_fmac_f32 v36, v24, v112
  v_fmac_f32 v37, v24, v113
  v_fmac_f32 v38, v24, v114
  v_fmac_f32 v39, v24, v115
  v_fmac_f32 v40, v32, v116
  v_fmac_f32 v41, v32, v117
  v_fmac_f32 v42, v32, v118
  v_fmac_f32 v43, v32, v119
  s_waitcnt lgkmcnt(0)
  v_fmac_f32 v36, v26, v120
  v_fmac_f32 v37, v26, v121
  v_fmac_f32 v38, v26, v122
  v_fmac_f32 v39, v26, v123
  v_fmac_f32 v40, v34, v124
  v_fmac_f32 v41, v34, v125
  v_fmac_f32 v42, v34, v126
  v_fmac_f32 v43, v34, v127
  v_cvt_pk_bf16_f32 v44, v36, v37
  v_cvt_pk_bf16_f32 v45, v38, v39
  v_cvt_pk_bf16_f32 v48, v40, v41
  v_cvt_pk_bf16_f32 v49, v42, v43
  buffer_store_dwordx4 v[44:47], v18, s[36:39], s52 offen sc1
  buffer_store_dwordx4 v[48:51], v18, s[36:39], s52 offen offset:1024 sc1
L_fin:
L_end:
  s_endpgm
.section .rodata,"a"
.p2align 6
.amdhsa_kernel recurrent_scan__gqa_block_cached__dense_activation_relu__decode_kernel
  .amdhsa_next_free_vgpr 256
  .amdhsa_next_free_sgpr 102
  .amdhsa_accum_offset 256
  .amdhsa_group_segment_fixed_size 0
  .amdhsa_kernarg_size 88
  .amdhsa_user_sgpr_count 2
  .amdhsa_user_sgpr_kernarg_segment_ptr 1
  .amdhsa_system_sgpr_workgroup_id_x 1
.end_amdhsa_kernel
```
